```python
import torch

def _softmax(x, axis=-1):
    return torch.softmax(x, dim=axis)
def _gelu(x):
    return torch.nn.functional.gelu(x, approximate="tanh")
def _silu(x):
    return torch.nn.functional.silu(x)
def _sigmoid(x):
    return torch.sigmoid(x)
def _layernorm(x, axis=-1, eps=1e-5):
    m = x.mean(dim=axis, keepdim=True)
    v = x.var(dim=axis, keepdim=True, unbiased=False)
    return (x - m) / torch.sqrt(v + eps)
def _scatter_add(tgt, idx, src, axis=0):
    return tgt.clone().index_add_(axis, idx, src)
def _segment_sum(src, seg, n):
    out = torch.zeros((n,) + src.shape[1:], dtype=src.dtype)
    return out.index_add_(0, seg, src)
def _pad(x, pw):
    flat = tuple(v for pair in reversed(pw) for v in pair)
    return torch.nn.functional.pad(x, flat)

kernel_name = 'sequential_preLN__grouped_kv_mqa__dense_activation_relu__prompt'

def setup_inputs():

    _w = (lambda a: (lambda t: t.to(torch.bfloat16) if t.is_floating_point() else t)(torch.as_tensor(a)))
    def _A_setup():
        B, S, D, H = 1, 2048, 512, 32
        Dh = D // H
        return {
            "x": _w((lambda *s: torch.randn(*s, dtype=torch.bfloat16) * 0.05)(B, S, D)),
            "wq": _w((lambda *s: torch.randn(*s, dtype=torch.bfloat16) * 0.05)(D, H * Dh)),
            "wk": _w((lambda *s: torch.randn(*s, dtype=torch.bfloat16) * 0.05)(D, Dh)),
            "wv": _w((lambda *s: torch.randn(*s, dtype=torch.bfloat16) * 0.05)(D, Dh)),
            "wo": _w((lambda *s: torch.randn(*s, dtype=torch.bfloat16) * 0.05)(H * Dh, D)),
        }
    _A_in = _A_setup()

    def _B_setup():
        B, S, D, Dff = 1, 2048, 512, 1792
        return {
            "x": _w((lambda *s: torch.randn(*s, dtype=torch.bfloat16) * 0.05)(B, S, D)),
            "w1": _w((lambda *s: torch.randn(*s, dtype=torch.bfloat16) * 0.05)(D, Dff)),
            "w2": _w((lambda *s: torch.randn(*s, dtype=torch.bfloat16) * 0.05)(Dff, D)),
        }
    _B_in = _B_setup()

    return {
        "A_x": _A_in["x"],
        "A_wq": _A_in["wq"],
        "A_wk": _A_in["wk"],
        "A_wv": _A_in["wv"],
        "A_wo": _A_in["wo"],
        "B_x": _B_in["x"],
        "B_w1": _B_in["w1"],
        "B_w2": _B_in["w2"],
    }

def reference(A_x, A_wq, A_wk, A_wv, A_wo, B_x, B_w1, B_w2):
    def _A_ref(x, wq, wk, wv, wo):
        B, S, D = x.shape
        H = 32
        Dh = D // H
        q = (lambda x, *d: x.permute(*d))((x @ wq).reshape(B, S, H, Dh), 0, 2, 1, 3)
        k = x @ wk
        v = x @ wv
        scores = torch.einsum("bhqd,bkd->bhqk", q, k) * (Dh ** -0.5)
        p = _softmax(scores, axis=-1)
        o = torch.einsum("bhqk,bkd->bhqd", p, v)
        return (lambda x, *d: x.permute(*d))(o, 0, 2, 1, 3).reshape(B, S, H * Dh) @ wo

    def _B_ref(x, w1, w2):
        h = torch.einsum("bsd,df->bsf", x, w1)
        zero = torch.zeros_like(h)
        h = torch.maximum(h, zero)
        return torch.einsum("bsf,fd->bsd", h, w2)

    x = A_x
    h = x + _A_ref(_layernorm(x, axis=-1), A_wq, A_wk, A_wv, A_wo)
    h2 = h + _B_ref(_layernorm(h, axis=-1), B_w1, B_w2)
    return h2
```

```asm
; @launch grid=(256,1,1) block=(256,1,1) lds=163840
.amdgcn_target "amdgcn-amd-amdhsa--gfx950"
.text
.globl sequential_preLN__grouped_kv_mqa__dense_activation_relu__prompt_kernel
.p2align 8
.type sequential_preLN__grouped_kv_mqa__dense_activation_relu__prompt_kernel,@function
sequential_preLN__grouped_kv_mqa__dense_activation_relu__prompt_kernel:
    s_cmp_ge_u32 s2, 0x100
    s_cbranch_scc1 L_end
    s_load_dwordx16 s[40:55], s[0:1], 0
    s_load_dwordx4 s[56:59], s[0:1], 64
    s_load_dwordx2 s[60:61], s[0:1], 80
    s_getpc_b64 s[62:63]
L_pc:
    v_lshrrev_b32 v10, 6, v0
    v_and_b32 v0, 63, v0
    s_lshr_b32 s86, s2, 3
    v_readfirstlane_b32 s36, v10
    s_and_b32 s3, s2, 7
    s_and_b32 s37, s86, 7
    s_lshr_b32 s87, s86, 3
    s_lshl_b32 s38, s3, 2
    s_add_u32 s38, s38, s87
    s_lshl_b32 s86, s86, 2
    s_add_u32 s86, s86, s36
    s_lshl_b32 s86, s86, 9
    v_and_b32 v10, 3, v0
    v_lshl_add_u32 v10, v10, 7, s86
    s_mov_b32 s87, L_end-L_pc
    v_min_u32 v10, s87, v10
    global_load_dword v14, v10, s[62:63]
    v_lshlrev_b32 v8, 4, v0
    v_and_b32 v192, 15, v0
    v_lshrrev_b32 v193, 4, v0
    v_lshrrev_b32 v194, 3, v0
    v_and_b32 v195, 7, v0
    v_xor_b32 v195, v195, v193
    v_lshlrev_b32 v195, 4, v195
    v_lshl_add_u32 v194, v194, 10, v195
    s_lshl_b32 s86, s38, 16
    s_lshl_b32 s87, s36, 8
    s_add_u32 s86, s86, s87
    v_add_u32 v194, s86, v194
    v_xor_b32 v195, 64, v194
    v_add_u32 v195, 7168, v195
    v_and_b32 v202, 16, v0
    v_lshlrev_b32 v202, 3, v202
    v_xor_b32 v202, v202, v8
    s_lshr_b32 s92, s37, 1
    s_lshl_b32 s88, s36, 12
    s_add_u32 s89, s88, 67584
    s_add_u32 m0, s88, 143360
    s_mov_b32 s14, 16384
    s_mov_b32 s15, 0x20000
    s_mov_b32 s6, 2097152
    s_mov_b32 s7, 0x20000
    s_bitcmp0_b32 s37, 0
    s_waitcnt lgkmcnt(0)
    s_cselect_b32 s12, s44, s46
    s_cselect_b32 s13, s45, s47
    s_mov_b32 s4, s40
    s_mov_b32 s5, s41
    buffer_load_dwordx4 v202, s[12:15], s88 offen offset:0 lds
    buffer_load_dwordx4 v202, s[12:15], s88 offen offset:1024 lds
    buffer_load_dwordx4 v202, s[12:15], s88 offen offset:2048 lds
    buffer_load_dwordx4 v202, s[12:15], s88 offen offset:3072 lds
    s_add_u32 s86, s92, 0
    s_and_b32 s86, s86, 3
    s_lshl_b32 s86, s86, 14
    s_add_u32 m0, s86, s89
    s_nop 0
    buffer_load_dwordx4 v194, s[4:7], s86 offen offset:0 lds
    buffer_load_dwordx4 v195, s[4:7], s86 offen offset:1024 lds
    s_add_u32 m0, m0, 2048
    s_add_u32 s86, s86, 128
    buffer_load_dwordx4 v194, s[4:7], s86 offen offset:0 lds
    buffer_load_dwordx4 v195, s[4:7], s86 offen offset:1024 lds
    s_mov_b32 s20, s60
    s_mov_b32 s21, s61
    s_mov_b32 s22, 18874368
    s_mov_b32 s23, 0x20000
    buffer_load_dword v15, off, s[20:23], 0 sc1
    s_mov_b32 s8, s42
    s_mov_b32 s9, s43
    s_mov_b32 s10, 524288
    s_mov_b32 s11, 0x20000
    s_add_u32 s24, s60, 163840
    s_addc_u32 s25, s61, 0
    s_mov_b32 s26, 135168
    s_mov_b32 s27, 0x20000
    s_mov_b32 s28, s56
    s_mov_b32 s29, s57
    s_mov_b32 s30, 2097152
    s_mov_b32 s31, 0x20000
    s_mul_i32 s86, s38, 327680
    s_add_u32 s86, s86, 4718592
    s_add_u32 s32, s60, s86
    s_addc_u32 s33, s61, 0
    s_mov_b32 s34, 327680
    s_mov_b32 s35, 0x20000
    s_getreg_b32 s84, hwreg(HW_REG_XCC_ID, 0, 4)
    s_mov_b32 s97, 0x3f803f80
    s_mul_i32 s86, s37, 7
    s_lshl_b32 s87, s36, 1
    s_add_u32 s88, s86, s87
    s_lshl_b32 s86, s88, 15
    s_add_u32 s86, s86, 851968
    s_add_u32 s12, s60, s86
    s_addc_u32 s13, s61, 0
    s_mov_b32 s86, 0x8000
    s_cmp_eq_u32 s36, 3
    s_cselect_b32 s14, s86, 0x10000
    s_lshl_b32 s88, s88, 11
    s_add_u32 s88, s88, 32768
    v_and_b32 v10, 31, v0
    v_lshrrev_b32 v12, 5, v0
    v_lshlrev_b32 v158, 6, v10
    v_lshl_add_u32 v158, v12, 5, v158
    v_add_u32 v158, s88, v158
    s_lshl_b32 s86, s36, 7
    v_xor_b32 v11, s86, v8
    s_lshl_b32 s86, s37, 2
    s_add_u32 s86, s86, s36
    s_lshl_b32 s87, s86, 14
    s_add_u32 s87, s87, 327680
    v_add_u32 v156, s87, v11
    s_mul_i32 s87, s86, 57344
    s_add_u32 s87, s87, 2686976
    v_add_u32 v157, s87, v11
    s_lshl_b32 s93, s86, 11
    s_add_u32 s91, s93, 114688
    s_mul_i32 s88, s38, 327680
    s_add_u32 s88, s88, 4718592
    s_add_u32 s87, s88, s93
    v_mov_b32 v128, s87
    s_add_u32 s87, s87, 112640
    v_mov_b32 v129, s87
    v_cmp_lt_u32 vcc, 15, v0
    s_nop 1
    v_cndmask_b32 v128, v128, v129, vcc
    s_mul_i32 s87, s86, 1536
    s_add_u32 s87, s87, s88
    s_add_u32 s87, s87, 61440
    v_mov_b32 v129, s87
    v_cmp_lt_u32 vcc, 31, v0
    s_nop 1
    v_cndmask_b32 v128, v128, v129, vcc
    s_lshl_b32 s87, s86, 10
    s_add_u32 s87, s87, s88
    s_add_u32 s87, s87, 190976
    v_mov_b32 v129, s87
    v_cmp_lt_u32 vcc, 43, v0
    s_nop 1
    v_cndmask_b32 v128, v128, v129, vcc
    s_lshl_b32 s87, s86, 9
    s_add_u32 s87, s87, s88
    s_add_u32 s87, s87, 173568
    v_mov_b32 v129, s87
    v_cmp_lt_u32 vcc, 51, v0
    s_nop 1
    v_cndmask_b32 v128, v128, v129, vcc
    s_lshl_b32 s87, s38, 16
    s_lshl_b32 s88, s86, 5
    s_add_u32 s87, s87, s88
    v_lshl_add_u32 v155, v10, 10, s87
    v_lshl_add_u32 v155, v12, 4, v155
    s_lshl_b32 s87, s38, 10
    s_add_u32 s87, s87, 15859712
    v_and_b32 v11, 7, v0
    s_sub_u32 s88, s87, 7168
    v_mov_b32 v129, s88
    v_cmp_lt_u32 vcc, 55, v0
    s_nop 1
    v_cndmask_b32 v128, v128, v129, vcc
    v_lshl_add_u32 v128, v0, 7, v128
    s_lshl_b32 s86, s86, 2
    s_add_u32 s90, s87, s86
    s_lshl_b32 s86, s36, 5
    s_add_u32 s87, s87, s86
    v_lshl_add_u32 v159, v11, 2, s87
    s_lshl_b32 s86, s36, 13
    s_add_u32 s86, s86, 15794176
    v_lshl_add_u32 v130, v0, 7, s86
    s_lshl_b32 s86, s38, 10
    s_add_u32 s86, s86, 15794176
    v_lshl_add_u32 v131, v11, 7, s86
    v_mov_b32 v1, 0xdddddddd
    v_mov_b32 v2, v8
    v_add_u32 v3, 65472, v8
    v_add_u32 v4, 130944, v8
    v_min_u32 v11, 16, v10
    v_lshlrev_b32 v11, 4, v11
    v_mul_u32_u24 v12, 272, v12
    s_mov_b32 s86, 1024
    v_add3_u32 v5, v11, v12, s86
    s_mov_b32 s86, 1179647
    s_mov_b32 s87, s86
    v_mov_b32 v11, 0x30000
    v_cndmask_b32 v5, v11, v5, s[86:87]
    v_add_u32 v6, 65472, v5
    v_add_u32 v7, 130944, v5
    v_add_u32 v9, 0x8000, v8
    v_mov_b32 v56, s97
    v_mov_b32 v57, s97
    v_mov_b32 v58, s97
    v_mov_b32 v59, s97
    v_lshrrev_b32 v196, 1, v192
    v_xor_b32 v196, v196, v193
    v_lshlrev_b32 v196, 4, v196
    v_lshl_add_u32 v196, v192, 7, v196
    s_lshl_b32 s86, s92, 14
    s_add_u32 s86, s86, s89
    v_add_u32 v198, s86, v196
    v_xor_b32 v199, 64, v198
    s_lshl_b32 s86, s36, 14
    s_add_u32 s86, s86, 67584
    v_add_u32 v196, s86, v196
    v_xor_b32 v197, 64, v196
    v_and_b32 v204, 1, v193
    v_lshlrev_b32 v204, 7, v204
    v_lshl_add_u32 v204, v192, 3, v204
    v_lshl_add_u32 v203, v193, 8, v204
    s_lshl_b32 s86, s36, 12
    s_add_u32 s86, s86, 143360
    v_add_u32 v203, s86, v203
    v_xor_b32 v204, 0x80, v203
    v_add_u32 v222, s86, v8
    s_lshl_b32 s86, s36, 2
    s_add_u32 s86, s86, 159744
    v_lshl_add_u32 v220, v192, 4, s86
    v_lshrrev_b32 v221, 2, v192
    v_cmp_eq_u32 vcc, v221, v193
    v_add_u32 v221, 256, v220
    s_nop 0
    v_cndmask_b32 v221, v221, v220, vcc
    v_lshrrev_b32 v200, 3, v0
    v_bfe_u32 v201, v0, 4, 1
    v_bfe_u32 v11, v0, 1, 2
    v_xor_b32 v201, v201, v11
    v_lshlrev_b32 v201, 5, v201
    v_and_b32 v11, 1, v0
    v_lshl_add_u32 v201, v11, 4, v201
    v_lshl_add_u32 v200, v200, 10, v201
    s_lshl_b32 s86, s37, 7
    v_add_u32 v200, s86, v200
    v_xor_b32 v201, 64, v200
    s_lshl_b32 s86, s2, 2
    s_add_u32 s86, s86, s36
    s_mov_b32 s83, 0x7ff00000
    s_mov_b32 s19, 0x20000
    s_cmp_ge_u32 s86, 576
    s_cbranch_scc1 L_u22
    s_cmp_ge_u32 s86, 128
    s_cbranch_scc1 L_u11
    s_mov_b32 s16, s48
    s_mov_b32 s17, s49
    s_mov_b32 s18, 524288
    s_and_b32 s87, s86, 7
    s_lshr_b32 s88, s86, 3
    s_lshl_b32 s94, s88, 15
    s_lshl_b32 s95, s87, 16
    s_lshl_b32 s88, s88, 12
    s_add_u32 s95, s95, s88
    s_add_u32 s95, s95, 327680
    s_mov_b32 s3, 4096
    s_mov_b32 s60, 1024
    s_mov_b32 s61, 5120
    s_mov_b32 s62, 5120
    s_mov_b32 s80, 2048
    s_mov_b32 s81, 1024
    s_branch L_uj3
L_u11:
    s_mov_b32 s16, s52
    s_mov_b32 s17, s53
    s_mov_b32 s18, 1835008
    s_sub_u32 s86, s86, 128
    s_mul_i32 s88, s86, 2341
    s_lshr_b32 s88, s88, 16
    s_mul_i32 s87, s88, 28
    s_sub_u32 s87, s86, s87
    s_mul_i32 s94, s88, 114688
    s_lshl_b32 s95, s87, 16
    s_lshl_b32 s86, s88, 11
    s_add_u32 s95, s95, s86
    s_add_u32 s95, s95, 851968
    s_lshl_b32 s83, s87, 12
    s_lshl_b32 s86, s88, 2
    s_add_u32 s83, s83, s86
    s_add_u32 s83, s83, 32768
    s_mov_b32 s3, 28672
    s_mov_b32 s60, 3584
    s_mov_b32 s61, 3584
    s_mov_b32 s62, 32256
    s_mov_b32 s80, 1024
    s_mov_b32 s81, 32768
    s_branch L_uj3
L_u22:
    s_mov_b32 s16, s54
    s_mov_b32 s17, s55
    s_mov_b32 s18, 1835008
    s_sub_u32 s86, s86, 576
    s_and_b32 s87, s86, 7
    s_lshr_b32 s88, s86, 3
    s_lshr_b32 s94, s88, 1
    s_lshl_b32 s94, s94, 6
    s_and_b32 s86, s88, 1
    s_add_u32 s94, s94, s86
    s_lshl_b32 s94, s94, 10
    s_mul_i32 s95, s87, 229376
    s_lshl_b32 s88, s88, 12
    s_add_u32 s95, s95, s88
    s_add_u32 s95, s95, 2686976
    s_mov_b32 s3, 8192
    s_mov_b32 s60, 2048
    s_mov_b32 s61, 10240
    s_mov_b32 s62, 10240
    s_mov_b32 s80, 2048
    s_mov_b32 s81, 1024
L_uj3:
    s_lshl_b32 s87, s87, 7
    s_add_u32 s94, s94, s87
    s_add_u32 s82, s80, s81
    v_lshrrev_b32 v205, 5, v0
    v_mul_u32_u24 v205, s3, v205
    v_and_b32 v206, 31, v0
    v_lshl_add_u32 v205, v206, 2, v205
    v_add_u32 v205, s94, v205
    v_add_u32 v206, s95, v8
    v_lshl_add_u32 v207, v0, 6, s83
    s_add_u32 s86, s38, 0
    s_and_b32 s86, s86, 3
    s_lshl_b32 s87, s36, 2
    s_add_u32 s86, s86, s87
    s_lshl_b32 m0, s86, 12
    s_lshl_b32 s86, s86, 15
    buffer_load_dwordx4 v200, s[8:11], s86 offen offset:0 lds
    s_add_u32 s86, s86, 7168
    buffer_load_dwordx4 v201, s[8:11], s86 offen offset:1024 lds
    s_add_u32 s86, s86, 7168
    buffer_load_dwordx4 v200, s[8:11], s86 offen offset:2048 lds
    s_add_u32 s86, s86, 7168
    buffer_load_dwordx4 v201, s[8:11], s86 offen offset:3072 lds
    s_waitcnt vmcnt(5)
    ds_read_b64_tr_b16 v[160:161], v203 offset:0
    ds_read_b64_tr_b16 v[162:163], v204 offset:0
    ds_read_b128 v[176:179], v198 offset:0
    ds_read_b64_tr_b16 v[164:165], v203 offset:1024
    ds_read_b64_tr_b16 v[166:167], v204 offset:1024
    ds_read_b128 v[180:183], v199 offset:0
    ds_read_b64_tr_b16 v[168:169], v203 offset:2048
    ds_read_b64_tr_b16 v[170:171], v204 offset:2048
    ds_read_b128 v[184:187], v198 offset:2048
    ds_read_b64_tr_b16 v[172:173], v203 offset:3072
    ds_read_b64_tr_b16 v[174:175], v204 offset:3072
    ds_read_b128 v[188:191], v199 offset:2048
    s_add_u32 s86, s92, 1
    s_and_b32 s86, s86, 3
    s_lshl_b32 s86, s86, 14
    s_add_u32 m0, s86, s89
    s_nop 0
    buffer_load_dwordx4 v194, s[4:7], s86 offen offset:0 lds
    buffer_load_dwordx4 v195, s[4:7], s86 offen offset:1024 lds
    s_add_u32 m0, m0, 2048
    s_add_u32 s86, s86, 128
    buffer_load_dwordx4 v194, s[4:7], s86 offen offset:0 lds
    buffer_load_dwordx4 v195, s[4:7], s86 offen offset:1024 lds
    s_bitcmp0_b32 s37, 0
    s_cbranch_scc0 L_vmm
    s_waitcnt lgkmcnt(9)
    v_mfma_f32_16x16x32_bf16 v[28:31], v[176:179], v[176:179], 0
    v_mfma_f32_16x16x32_bf16 v[24:27], v[56:59], v[176:179], 0
    v_mfma_f32_16x16x32_bf16 v[20:23], v[56:59], v[160:163], 0
    v_mfma_f32_16x16x32_bf16 v[16:19], v[160:163], v[176:179], 0
    s_waitcnt lgkmcnt(6)
    v_mfma_f32_16x16x32_bf16 v[28:31], v[180:183], v[180:183], v[28:31]
    v_mfma_f32_16x16x32_bf16 v[24:27], v[56:59], v[180:183], v[24:27]
    v_mfma_f32_16x16x32_bf16 v[20:23], v[56:59], v[164:167], v[20:23]
    v_mfma_f32_16x16x32_bf16 v[16:19], v[164:167], v[180:183], v[16:19]
    s_waitcnt lgkmcnt(3)
    v_mfma_f32_16x16x32_bf16 v[28:31], v[184:187], v[184:187], v[28:31]
    v_mfma_f32_16x16x32_bf16 v[24:27], v[56:59], v[184:187], v[24:27]
    v_mfma_f32_16x16x32_bf16 v[20:23], v[56:59], v[168:171], v[20:23]
    v_mfma_f32_16x16x32_bf16 v[16:19], v[168:171], v[184:187], v[16:19]
    s_waitcnt lgkmcnt(0)
    v_mfma_f32_16x16x32_bf16 v[28:31], v[188:191], v[188:191], v[28:31]
    v_mfma_f32_16x16x32_bf16 v[24:27], v[56:59], v[188:191], v[24:27]
    v_mfma_f32_16x16x32_bf16 v[20:23], v[56:59], v[172:175], v[20:23]
    v_mfma_f32_16x16x32_bf16 v[16:19], v[172:175], v[188:191], v[16:19]
    s_nop 7
    s_branch L_mmd
L_vmm:
    s_waitcnt lgkmcnt(9)
    v_mfma_f32_16x16x32_bf16 v[28:31], v[176:179], v[176:179], 0
    v_mfma_f32_16x16x32_bf16 v[24:27], v[56:59], v[176:179], 0
    v_mfma_f32_16x16x32_bf16 v[20:23], v[56:59], v[160:163], 0
    v_mfma_f32_16x16x32_bf16 v[16:19], v[176:179], v[160:163], 0
    s_waitcnt lgkmcnt(6)
    v_mfma_f32_16x16x32_bf16 v[28:31], v[180:183], v[180:183], v[28:31]
    v_mfma_f32_16x16x32_bf16 v[24:27], v[56:59], v[180:183], v[24:27]
    v_mfma_f32_16x16x32_bf16 v[20:23], v[56:59], v[164:167], v[20:23]
    v_mfma_f32_16x16x32_bf16 v[16:19], v[180:183], v[164:167], v[16:19]
    s_waitcnt lgkmcnt(3)
    v_mfma_f32_16x16x32_bf16 v[28:31], v[184:187], v[184:187], v[28:31]
    v_mfma_f32_16x16x32_bf16 v[24:27], v[56:59], v[184:187], v[24:27]
    v_mfma_f32_16x16x32_bf16 v[20:23], v[56:59], v[168:171], v[20:23]
    v_mfma_f32_16x16x32_bf16 v[16:19], v[184:187], v[168:171], v[16:19]
    s_waitcnt lgkmcnt(0)
    v_mfma_f32_16x16x32_bf16 v[28:31], v[188:191], v[188:191], v[28:31]
    v_mfma_f32_16x16x32_bf16 v[24:27], v[56:59], v[188:191], v[24:27]
    v_mfma_f32_16x16x32_bf16 v[20:23], v[56:59], v[172:175], v[20:23]
    v_mfma_f32_16x16x32_bf16 v[16:19], v[188:191], v[172:175], v[16:19]
L_mmd:
    s_mov_b32 s86, 0x00100001
    s_mov_b32 s87, 0x10000100
    s_nop 2
    v_cndmask_b32 v32, 0, v28, s[86:87]
    s_lshl_b64 s[86:87], s[86:87], 1
    v_cndmask_b32 v32, v32, v29, s[86:87]
    s_lshl_b64 s[86:87], s[86:87], 1
    v_cndmask_b32 v32, v32, v30, s[86:87]
    s_lshl_b64 s[86:87], s[86:87], 1
    v_cndmask_b32 v32, v32, v31, s[86:87]
    ds_write_b32 v220, v24
    ds_write_b32 v220, v20 offset:256
    ds_write_b32 v221, v32 offset:512
    ds_write_b128 v222, v[16:19]
    s_add_u32 s86, s92, 2
    s_and_b32 s86, s86, 3
    s_lshl_b32 s86, s86, 14
    s_add_u32 m0, s86, s89
    s_nop 0
    buffer_load_dwordx4 v194, s[4:7], s86 offen offset:0 lds
    buffer_load_dwordx4 v195, s[4:7], s86 offen offset:1024 lds
    s_add_u32 m0, m0, 2048
    s_add_u32 s86, s86, 128
    buffer_load_dwordx4 v194, s[4:7], s86 offen offset:0 lds
    buffer_load_dwordx4 v195, s[4:7], s86 offen offset:1024 lds
    s_waitcnt lgkmcnt(0)
    s_barrier
    s_add_u32 s86, s92, 3
    s_and_b32 s86, s86, 3
    s_lshl_b32 s86, s86, 14
    s_add_u32 m0, s86, s89
    s_nop 0
    buffer_load_dwordx4 v194, s[4:7], s86 offen offset:0 lds
    buffer_load_dwordx4 v195, s[4:7], s86 offen offset:1024 lds
    s_add_u32 m0, m0, 2048
    s_add_u32 s86, s86, 128
    buffer_load_dwordx4 v194, s[4:7], s86 offen offset:0 lds
    buffer_load_dwordx4 v195, s[4:7], s86 offen offset:1024 lds
    s_cmp_eq_u32 s36, 0
    s_cbranch_scc1 L_fin
    s_add_u32 s86, s38, 1
    s_and_b32 s86, s86, 3
    s_lshl_b32 s87, s36, 2
    s_add_u32 s86, s86, s87
    s_lshl_b32 m0, s86, 12
    s_lshl_b32 s86, s86, 15
    buffer_load_dwordx4 v200, s[8:11], s86 offen offset:0 lds
    s_add_u32 s86, s86, 7168
    buffer_load_dwordx4 v201, s[8:11], s86 offen offset:1024 lds
    s_add_u32 s86, s86, 7168
    buffer_load_dwordx4 v200, s[8:11], s86 offen offset:2048 lds
    s_add_u32 s86, s86, 7168
    buffer_load_dwordx4 v201, s[8:11], s86 offen offset:3072 lds
    s_waitcnt vmcnt(4)
L_find:
    s_barrier
    ds_read_b128 v[64:67], v196 offset:0
    ds_read_b128 v[68:71], v197 offset:0
    ds_read_b128 v[72:75], v196 offset:2048
    ds_read_b128 v[76:79], v197 offset:2048
    ds_read_b128 v[80:83], v196 offset:4096
    ds_read_b128 v[84:87], v197 offset:4096
    ds_read_b128 v[88:91], v196 offset:6144
    ds_read_b128 v[92:95], v197 offset:6144
    v_readfirstlane_b32 s39, v15
    s_add_u32 s39, s39, 0x9e3779b0
    s_and_b32 s39, s39, -16
    s_or_b32 s84, s84, s39
    s_waitcnt lgkmcnt(7)
    v_mfma_f32_16x16x32_bf16 v[44:47], v[64:67], v[64:67], 0
    ds_read_b128 v[96:99], v196 offset:8192
    v_mfma_f32_16x16x32_bf16 v[48:51], v[56:59], v[64:67], 0
    s_add_u32 s86, s38, 2
    s_and_b32 s86, s86, 3
    s_lshl_b32 s87, s36, 2
    s_add_u32 s86, s86, s87
    s_lshl_b32 m0, s86, 12
    s_lshl_b32 s86, s86, 15
    buffer_load_dwordx4 v200, s[8:11], s86 offen offset:0 lds
    s_add_u32 s86, s86, 7168
    s_waitcnt lgkmcnt(7)
    v_mfma_f32_16x16x32_bf16 v[44:47], v[68:71], v[68:71], v[44:47]
    ds_read_b128 v[100:103], v197 offset:8192
    v_mfma_f32_16x16x32_bf16 v[48:51], v[56:59], v[68:71], v[48:51]
    buffer_load_dwordx4 v201, s[8:11], s86 offen offset:1024 lds
    s_add_u32 s86, s86, 7168
    s_waitcnt lgkmcnt(7)
    v_mfma_f32_16x16x32_bf16 v[44:47], v[72:75], v[72:75], v[44:47]
    ds_read_b128 v[104:107], v196 offset:10240
    v_mfma_f32_16x16x32_bf16 v[48:51], v[56:59], v[72:75], v[48:51]
    buffer_load_dwordx4 v200, s[8:11], s86 offen offset:2048 lds
    s_add_u32 s86, s86, 7168
    s_waitcnt lgkmcnt(7)
    v_mfma_f32_16x16x32_bf16 v[44:47], v[76:79], v[76:79], v[44:47]
    ds_read_b128 v[108:111], v197 offset:10240
    v_mfma_f32_16x16x32_bf16 v[48:51], v[56:59], v[76:79], v[48:51]
    buffer_load_dwordx4 v201, s[8:11], s86 offen offset:3072 lds
    s_waitcnt lgkmcnt(7)
    v_mfma_f32_16x16x32_bf16 v[44:47], v[80:83], v[80:83], v[44:47]
    ds_read_b128 v[112:115], v196 offset:12288
    v_mfma_f32_16x16x32_bf16 v[48:51], v[56:59], v[80:83], v[48:51]
    s_add_u32 s86, s38, 3
    s_and_b32 s86, s86, 3
    s_lshl_b32 s87, s36, 2
    s_add_u32 s86, s86, s87
    s_lshl_b32 m0, s86, 12
    s_lshl_b32 s86, s86, 15
    buffer_load_dwordx4 v200, s[8:11], s86 offen offset:0 lds
    s_add_u32 s86, s86, 7168
    s_waitcnt lgkmcnt(7)
    v_mfma_f32_16x16x32_bf16 v[44:47], v[84:87], v[84:87], v[44:47]
    ds_read_b128 v[116:119], v197 offset:12288
    v_mfma_f32_16x16x32_bf16 v[48:51], v[56:59], v[84:87], v[48:51]
    buffer_load_dwordx4 v201, s[8:11], s86 offen offset:1024 lds
    s_add_u32 s86, s86, 7168
    s_waitcnt lgkmcnt(7)
    v_mfma_f32_16x16x32_bf16 v[44:47], v[88:91], v[88:91], v[44:47]
    ds_read_b128 v[120:123], v196 offset:14336
    v_mfma_f32_16x16x32_bf16 v[48:51], v[56:59], v[88:91], v[48:51]
    buffer_load_dwordx4 v200, s[8:11], s86 offen offset:2048 lds
    s_add_u32 s86, s86, 7168
    s_waitcnt lgkmcnt(7)
    v_mfma_f32_16x16x32_bf16 v[44:47], v[92:95], v[92:95], v[44:47]
    ds_read_b128 v[124:127], v197 offset:14336
    v_mfma_f32_16x16x32_bf16 v[48:51], v[56:59], v[92:95], v[48:51]
    buffer_load_dwordx4 v201, s[8:11], s86 offen offset:3072 lds
    s_waitcnt lgkmcnt(7)
    v_mfma_f32_16x16x32_bf16 v[44:47], v[96:99], v[96:99], v[44:47]
    v_bfe_u32 v11, v0, 2, 2
    v_lshl_add_u32 v11, v193, 3, v11
    v_mfma_f32_16x16x32_bf16 v[48:51], v[56:59], v[96:99], v[48:51]
    s_lshl_b32 s55, s38, 3
    s_add_u32 s55, s55, s37
    s_lshl_b32 s55, s55, 7
    s_add_u32 s55, s55, 15728640
    v_mov_b32 v10, s39
    s_cmp_eq_u32 s36, 0
    s_cselect_b64 exec, 1, 0
    s_waitcnt vmcnt(12)
    buffer_store_dword v10, off, s[20:23], s55 sc1
    s_mov_b64 exec, -1
    s_waitcnt lgkmcnt(6)
    v_mfma_f32_16x16x32_bf16 v[44:47], v[100:103], v[100:103], v[44:47]
    v_lshlrev_b32 v11, 7, v11
    v_and_b32 v12, 3, v0
    v_mfma_f32_16x16x32_bf16 v[48:51], v[56:59], v[100:103], v[48:51]
    v_lshl_add_u32 v11, v12, 3, v11
    v_bfe_u32 v12, v0, 3, 2
    v_xor_b32 v12, s36, v12
    s_mov_b32 s3, 0
    buffer_load_dword v224, v205, s[16:19], s3 offen
    s_add_u32 s3, s3, s60
    buffer_load_dword v225, v205, s[16:19], s3 offen
    s_add_u32 s3, s3, s60
    s_waitcnt lgkmcnt(5)
    v_mfma_f32_16x16x32_bf16 v[44:47], v[104:107], v[104:107], v[44:47]
    v_lshl_add_u32 v208, v12, 5, v11
    v_xor_b32 v209, 32, v208
    v_mfma_f32_16x16x32_bf16 v[48:51], v[56:59], v[104:107], v[48:51]
    v_xor_b32 v210, 64, v208
    v_xor_b32 v211, 0x60, v208
    v_lshrrev_b32 v12, 1, v193
    buffer_load_dword v226, v205, s[16:19], s3 offen
    s_add_u32 s3, s3, s60
    buffer_load_dword v227, v205, s[16:19], s3 offen
    s_add_u32 s3, s3, s61
    s_waitcnt lgkmcnt(4)
    v_mfma_f32_16x16x32_bf16 v[44:47], v[108:111], v[108:111], v[44:47]
    v_lshl_add_u32 v12, v12, 5, v192
    v_and_b32 v11, 1, v193
    v_mfma_f32_16x16x32_bf16 v[48:51], v[56:59], v[108:111], v[48:51]
    v_lshlrev_b32 v11, 3, v11
    v_lshl_add_u32 v11, v12, 4, v11
    s_lshr_b32 s86, s36, 1
    buffer_load_dword v228, v205, s[16:19], s3 offen
    s_add_u32 s3, s3, s60
    buffer_load_dword v229, v205, s[16:19], s3 offen
    s_add_u32 s3, s3, s60
    s_waitcnt lgkmcnt(3)
    v_mfma_f32_16x16x32_bf16 v[44:47], v[112:115], v[112:115], v[44:47]
    s_lshl_b32 s86, s86, 10
    s_and_b32 s87, s36, 1
    v_mfma_f32_16x16x32_bf16 v[48:51], v[56:59], v[112:115], v[48:51]
    s_lshl_b32 s87, s87, 8
    s_add_u32 s86, s86, s87
    s_lshl_b32 s87, s36, 11
    buffer_load_dword v230, v205, s[16:19], s3 offen
    s_add_u32 s3, s3, s60
    buffer_load_dword v231, v205, s[16:19], s3 offen
    s_add_u32 s3, s3, s62
    s_waitcnt lgkmcnt(2)
    v_mfma_f32_16x16x32_bf16 v[44:47], v[116:119], v[116:119], v[44:47]
    s_add_u32 s86, s86, s87
    v_add_u32 v11, s86, v11
    v_mfma_f32_16x16x32_bf16 v[48:51], v[56:59], v[116:119], v[48:51]
    v_add_u32 v212, 135168, v11
    v_xor_b32 v12, 0x800, v11
    v_add_u32 v213, 135168, v12
    buffer_load_dword v232, v205, s[16:19], s3 offen
    s_add_u32 s3, s3, s60
    buffer_load_dword v233, v205, s[16:19], s3 offen
    s_add_u32 s3, s3, s60
    s_waitcnt lgkmcnt(1)
    v_mfma_f32_16x16x32_bf16 v[44:47], v[120:123], v[120:123], v[44:47]
    v_xor_b32 v12, 0x1000, v11
    v_add_u32 v214, 135168, v12
    v_mfma_f32_16x16x32_bf16 v[48:51], v[56:59], v[120:123], v[48:51]
    v_xor_b32 v12, 0x1800, v11
    v_add_u32 v215, 135168, v12
    s_lshl_b32 s86, s36, 6
    buffer_load_dword v234, v205, s[16:19], s3 offen
    s_add_u32 s3, s3, s60
    buffer_load_dword v235, v205, s[16:19], s3 offen
    s_add_u32 s3, s3, s61
    s_waitcnt lgkmcnt(0)
    v_mfma_f32_16x16x32_bf16 v[44:47], v[124:127], v[124:127], v[44:47]
    s_add_u32 s86, s86, 160768
    v_lshl_add_u32 v216, v193, 4, s86
    v_mfma_f32_16x16x32_bf16 v[48:51], v[56:59], v[124:127], v[48:51]
    v_xor_b32 v217, 64, v216
    v_xor_b32 v218, 0x80, v216
    v_xor_b32 v219, 0xc0, v216
    buffer_load_dword v236, v205, s[16:19], s3 offen
    s_add_u32 s3, s3, s60
    buffer_load_dword v237, v205, s[16:19], s3 offen
    s_add_u32 s3, s3, s60
    v_subrev_u32 v223, 65536, v130
    s_mov_b32 s86, 0x00100001
    s_mov_b32 s87, 0x10000100
    v_cndmask_b32 v52, 0, v44, s[86:87]
    s_lshl_b64 s[86:87], s[86:87], 1
    v_cndmask_b32 v52, v52, v45, s[86:87]
    s_lshl_b64 s[86:87], s[86:87], 1
    v_cndmask_b32 v52, v52, v46, s[86:87]
    s_lshl_b64 s[86:87], s[86:87], 1
    v_cndmask_b32 v52, v52, v47, s[86:87]
    v_mov_b32 v53, v52
    s_mov_b32 s94, 0x3b000000
    s_nop 0
    v_permlane32_swap_b32 v52, v53
    v_add_f32 v52, v52, v53
    v_mov_b32 v53, v52
    s_nop 1
    v_permlane16_swap_b32 v52, v53
    v_add_f32 v52, v52, v53
    v_mul_f32 v53, 0xbb000000, v48
    v_mul_f32 v54, v53, v53
    v_fma_f32 v54, v52, s94, -v54
    v_max_f32 v54, 0, v54
    v_add_f32 v54, 0x3727c5ac, v54
    v_rsq_f32 v54, v54
    s_nop 0
    v_mul_f32 v55, 0x3eb8aa3b, v54
    buffer_load_dword v238, v205, s[16:19], s3 offen
    s_add_u32 s3, s3, s60
    buffer_load_dword v239, v205, s[16:19], s3 offen
    s_waitcnt vmcnt(17)
    s_barrier
    ds_read_b64_tr_b16 v[160:161], v208 offset:0
    ds_read_b64_tr_b16 v[162:163], v208 offset:512
    ds_read_b64_tr_b16 v[164:165], v209 offset:0
    ds_read_b64_tr_b16 v[166:167], v209 offset:512
    ds_read_b64_tr_b16 v[168:169], v210 offset:0
    ds_read_b64_tr_b16 v[170:171], v210 offset:512
    ds_read_b64_tr_b16 v[172:173], v211 offset:0
    ds_read_b64_tr_b16 v[174:175], v211 offset:512
    ds_read_b64_tr_b16 v[176:177], v208 offset:4096
    ds_read_b64_tr_b16 v[178:179], v208 offset:4608
    ds_read_b64_tr_b16 v[180:181], v209 offset:4096
    ds_read_b64_tr_b16 v[182:183], v209 offset:4608
    ds_read_b64_tr_b16 v[184:185], v210 offset:4096
    ds_read_b64_tr_b16 v[186:187], v210 offset:4608
    s_waitcnt lgkmcnt(12)
    v_mfma_f32_16x16x32_bf16 v[16:19], v[160:163], v[64:67], 0
    ds_read_b64_tr_b16 v[188:189], v211 offset:4096
    ds_read_b64_tr_b16 v[190:191], v211 offset:4608
    v_mfma_f32_16x16x32_bf16 v[32:35], v[160:163], v[56:59], 0
    s_mov_b32 s76, 4096
    s_mov_b32 s77, 8192
    s_mov_b32 s79, 0x8000
    s_waitcnt lgkmcnt(12)
    v_mfma_f32_16x16x32_bf16 v[20:23], v[164:167], v[64:67], 0
    ds_read_b64_tr_b16 v[160:161], v208 offset:8192
    ds_read_b64_tr_b16 v[162:163], v208 offset:8704
    s_waitcnt lgkmcnt(12)
    v_mfma_f32_16x16x32_bf16 v[24:27], v[168:171], v[64:67], 0
    ds_read_b64_tr_b16 v[164:165], v209 offset:8192
    ds_read_b64_tr_b16 v[166:167], v209 offset:8704
    s_waitcnt lgkmcnt(12)
    v_mfma_f32_16x16x32_bf16 v[28:31], v[172:175], v[64:67], 0
    ds_read_b64_tr_b16 v[168:169], v210 offset:8192
    ds_read_b64_tr_b16 v[170:171], v210 offset:8704
    s_waitcnt lgkmcnt(12)
    v_mfma_f32_16x16x32_bf16 v[16:19], v[176:179], v[68:71], v[16:19]
    ds_read_b64_tr_b16 v[172:173], v211 offset:8192
    ds_read_b64_tr_b16 v[174:175], v211 offset:8704
    v_mfma_f32_16x16x32_bf16 v[32:35], v[176:179], v[56:59], v[32:35]
    s_and_b32 s78, s38, 0
    s_lshl_b32 s64, s78, 13
    s_lshl_b32 s72, s78, 12
    s_waitcnt lgkmcnt(12)
    v_mfma_f32_16x16x32_bf16 v[20:23], v[180:183], v[68:71], v[20:23]
    ds_read_b64_tr_b16 v[176:177], v208 offset:12288
    ds_read_b64_tr_b16 v[178:179], v208 offset:12800
    s_waitcnt lgkmcnt(12)
    v_mfma_f32_16x16x32_bf16 v[24:27], v[184:187], v[68:71], v[24:27]
    ds_read_b64_tr_b16 v[180:181], v209 offset:12288
    ds_read_b64_tr_b16 v[182:183], v209 offset:12800
    s_waitcnt lgkmcnt(12)
    v_mfma_f32_16x16x32_bf16 v[28:31], v[188:191], v[68:71], v[28:31]
    ds_read_b64_tr_b16 v[184:185], v210 offset:12288
    ds_read_b64_tr_b16 v[186:187], v210 offset:12800
    s_waitcnt lgkmcnt(12)
    v_mfma_f32_16x16x32_bf16 v[16:19], v[160:163], v[72:75], v[16:19]
    ds_read_b64_tr_b16 v[188:189], v211 offset:12288
    ds_read_b64_tr_b16 v[190:191], v211 offset:12800
    v_mfma_f32_16x16x32_bf16 v[32:35], v[160:163], v[56:59], v[32:35]
    s_mul_i32 s86, s78, 7
    s_add_u32 s86, s86, 1
    s_lshr_b32 s86, s86, 1
    s_waitcnt lgkmcnt(12)
    v_mfma_f32_16x16x32_bf16 v[20:23], v[164:167], v[72:75], v[20:23]
    ds_read_b64_tr_b16 v[160:161], v208 offset:16384
    ds_read_b64_tr_b16 v[162:163], v208 offset:16896
    s_waitcnt lgkmcnt(12)
    v_mfma_f32_16x16x32_bf16 v[24:27], v[168:171], v[72:75], v[24:27]
    ds_read_b64_tr_b16 v[164:165], v209 offset:16384
    ds_read_b64_tr_b16 v[166:167], v209 offset:16896
    s_waitcnt lgkmcnt(12)
    v_mfma_f32_16x16x32_bf16 v[28:31], v[172:175], v[72:75], v[28:31]
    ds_read_b64_tr_b16 v[168:169], v210 offset:16384
    ds_read_b64_tr_b16 v[170:171], v210 offset:16896
    s_waitcnt lgkmcnt(12)
    v_mfma_f32_16x16x32_bf16 v[16:19], v[176:179], v[76:79], v[16:19]
    ds_read_b64_tr_b16 v[172:173], v211 offset:16384
    ds_read_b64_tr_b16 v[174:175], v211 offset:16896
    v_mfma_f32_16x16x32_bf16 v[32:35], v[176:179], v[56:59], v[32:35]
    s_lshl_b32 s40, s86, 12
    s_add_u32 s86, s64, 4096
    s_and_b32 s65, s86, 0x7fff
    s_waitcnt lgkmcnt(12)
    v_mfma_f32_16x16x32_bf16 v[20:23], v[180:183], v[76:79], v[20:23]
    ds_read_b64_tr_b16 v[176:177], v208 offset:20480
    ds_read_b64_tr_b16 v[178:179], v208 offset:20992
    s_waitcnt lgkmcnt(12)
    v_mfma_f32_16x16x32_bf16 v[24:27], v[184:187], v[76:79], v[24:27]
    ds_read_b64_tr_b16 v[180:181], v209 offset:20480
    ds_read_b64_tr_b16 v[182:183], v209 offset:20992
    s_waitcnt lgkmcnt(12)
    v_mfma_f32_16x16x32_bf16 v[28:31], v[188:191], v[76:79], v[28:31]
    ds_read_b64_tr_b16 v[184:185], v210 offset:20480
    ds_read_b64_tr_b16 v[186:187], v210 offset:20992
    s_waitcnt lgkmcnt(12)
    v_mfma_f32_16x16x32_bf16 v[16:19], v[160:163], v[80:83], v[16:19]
    ds_read_b64_tr_b16 v[188:189], v211 offset:20480
    ds_read_b64_tr_b16 v[190:191], v211 offset:20992
    v_mfma_f32_16x16x32_bf16 v[32:35], v[160:163], v[56:59], v[32:35]
    s_add_u32 s86, s65, 4096
    s_and_b32 s66, s86, 0x7fff
    s_add_u32 s86, s66, 4096
    s_waitcnt lgkmcnt(12)
    v_mfma_f32_16x16x32_bf16 v[20:23], v[164:167], v[80:83], v[20:23]
    ds_read_b64_tr_b16 v[160:161], v208 offset:24576
    ds_read_b64_tr_b16 v[162:163], v208 offset:25088
    s_waitcnt lgkmcnt(12)
    v_mfma_f32_16x16x32_bf16 v[24:27], v[168:171], v[80:83], v[24:27]
    ds_read_b64_tr_b16 v[164:165], v209 offset:24576
    ds_read_b64_tr_b16 v[166:167], v209 offset:25088
    s_waitcnt lgkmcnt(12)
    v_mfma_f32_16x16x32_bf16 v[28:31], v[172:175], v[80:83], v[28:31]
    ds_read_b64_tr_b16 v[168:169], v210 offset:24576
    ds_read_b64_tr_b16 v[170:171], v210 offset:25088
    s_waitcnt lgkmcnt(12)
    v_mfma_f32_16x16x32_bf16 v[16:19], v[176:179], v[84:87], v[16:19]
    ds_read_b64_tr_b16 v[172:173], v211 offset:24576
    ds_read_b64_tr_b16 v[174:175], v211 offset:25088
    v_mfma_f32_16x16x32_bf16 v[32:35], v[176:179], v[56:59], v[32:35]
    s_and_b32 s67, s86, 0x7fff
    s_add_u32 s86, s67, 4096
    s_and_b32 s68, s86, 0x7fff
    s_waitcnt lgkmcnt(12)
    v_mfma_f32_16x16x32_bf16 v[20:23], v[180:183], v[84:87], v[20:23]
    ds_read_b64_tr_b16 v[176:177], v208 offset:28672
    ds_read_b64_tr_b16 v[178:179], v208 offset:29184
    s_waitcnt lgkmcnt(12)
    v_mfma_f32_16x16x32_bf16 v[24:27], v[184:187], v[84:87], v[24:27]
    ds_read_b64_tr_b16 v[180:181], v209 offset:28672
    ds_read_b64_tr_b16 v[182:183], v209 offset:29184
    s_waitcnt lgkmcnt(12)
    v_mfma_f32_16x16x32_bf16 v[28:31], v[188:191], v[84:87], v[28:31]
    ds_read_b64_tr_b16 v[184:185], v210 offset:28672
    ds_read_b64_tr_b16 v[186:187], v210 offset:29184
    s_waitcnt lgkmcnt(12)
    v_mfma_f32_16x16x32_bf16 v[16:19], v[160:163], v[88:91], v[16:19]
    ds_read_b64_tr_b16 v[188:189], v211 offset:28672
    ds_read_b64_tr_b16 v[190:191], v211 offset:29184
    v_mfma_f32_16x16x32_bf16 v[32:35], v[160:163], v[56:59], v[32:35]
    s_add_u32 s86, s68, 4096
    s_and_b32 s69, s86, 0x7fff
    s_add_u32 s86, s69, 4096
    s_waitcnt lgkmcnt(12)
    v_mfma_f32_16x16x32_bf16 v[20:23], v[164:167], v[88:91], v[20:23]
    ds_read_b64_tr_b16 v[160:161], v208 offset:32768
    ds_read_b64_tr_b16 v[162:163], v208 offset:33280
    s_waitcnt lgkmcnt(12)
    v_mfma_f32_16x16x32_bf16 v[24:27], v[168:171], v[88:91], v[24:27]
    ds_read_b64_tr_b16 v[164:165], v209 offset:32768
    ds_read_b64_tr_b16 v[166:167], v209 offset:33280
    s_waitcnt lgkmcnt(12)
    v_mfma_f32_16x16x32_bf16 v[28:31], v[172:175], v[88:91], v[28:31]
    ds_read_b64_tr_b16 v[168:169], v210 offset:32768
    ds_read_b64_tr_b16 v[170:171], v210 offset:33280
    s_waitcnt lgkmcnt(12)
    v_mfma_f32_16x16x32_bf16 v[16:19], v[176:179], v[92:95], v[16:19]
    ds_read_b64_tr_b16 v[172:173], v211 offset:32768
    ds_read_b64_tr_b16 v[174:175], v211 offset:33280
    v_mfma_f32_16x16x32_bf16 v[32:35], v[176:179], v[56:59], v[32:35]
    s_and_b32 s70, s86, 0x7fff
    s_add_u32 s86, s70, 4096
    s_and_b32 s71, s86, 0x7fff
    s_waitcnt lgkmcnt(12)
    v_mfma_f32_16x16x32_bf16 v[20:23], v[180:183], v[92:95], v[20:23]
    ds_read_b64_tr_b16 v[176:177], v208 offset:36864
    ds_read_b64_tr_b16 v[178:179], v208 offset:37376
    s_waitcnt lgkmcnt(12)
    v_mfma_f32_16x16x32_bf16 v[24:27], v[184:187], v[92:95], v[24:27]
    ds_read_b64_tr_b16 v[180:181], v209 offset:36864
    ds_read_b64_tr_b16 v[182:183], v209 offset:37376
    s_waitcnt lgkmcnt(12)
    v_mfma_f32_16x16x32_bf16 v[28:31], v[188:191], v[92:95], v[28:31]
    ds_read_b64_tr_b16 v[184:185], v210 offset:36864
    ds_read_b64_tr_b16 v[186:187], v210 offset:37376
    s_waitcnt lgkmcnt(12)
    v_mfma_f32_16x16x32_bf16 v[16:19], v[160:163], v[96:99], v[16:19]
    ds_read_b64_tr_b16 v[188:189], v211 offset:36864
    ds_read_b64_tr_b16 v[190:191], v211 offset:37376
    v_mfma_f32_16x16x32_bf16 v[32:35], v[160:163], v[56:59], v[32:35]
    s_add_u32 s86, s72, 4096
    s_and_b32 s73, s86, 0x3fff
    s_add_u32 s86, s73, 4096
    s_waitcnt lgkmcnt(12)
    v_mfma_f32_16x16x32_bf16 v[20:23], v[164:167], v[96:99], v[20:23]
    ds_read_b64_tr_b16 v[160:161], v208 offset:40960
    ds_read_b64_tr_b16 v[162:163], v208 offset:41472
    s_waitcnt lgkmcnt(12)
    v_mfma_f32_16x16x32_bf16 v[24:27], v[168:171], v[96:99], v[24:27]
    ds_read_b64_tr_b16 v[164:165], v209 offset:40960
    ds_read_b64_tr_b16 v[166:167], v209 offset:41472
    s_waitcnt lgkmcnt(12)
    v_mfma_f32_16x16x32_bf16 v[28:31], v[172:175], v[96:99], v[28:31]
    ds_read_b64_tr_b16 v[168:169], v210 offset:40960
    ds_read_b64_tr_b16 v[170:171], v210 offset:41472
    s_waitcnt lgkmcnt(12)
    v_mfma_f32_16x16x32_bf16 v[16:19], v[176:179], v[100:103], v[16:19]
    ds_read_b64_tr_b16 v[172:173], v211 offset:40960
    ds_read_b64_tr_b16 v[174:175], v211 offset:41472
    v_mfma_f32_16x16x32_bf16 v[32:35], v[176:179], v[56:59], v[32:35]
    s_and_b32 s74, s86, 0x3fff
    s_add_u32 s86, s74, 4096
    s_and_b32 s75, s86, 0x3fff
    s_waitcnt lgkmcnt(12)
    v_mfma_f32_16x16x32_bf16 v[20:23], v[180:183], v[100:103], v[20:23]
    ds_read_b64_tr_b16 v[176:177], v208 offset:45056
    ds_read_b64_tr_b16 v[178:179], v208 offset:45568
    s_waitcnt lgkmcnt(12)
    v_mfma_f32_16x16x32_bf16 v[24:27], v[184:187], v[100:103], v[24:27]
    ds_read_b64_tr_b16 v[180:181], v209 offset:45056
    ds_read_b64_tr_b16 v[182:183], v209 offset:45568
    s_waitcnt lgkmcnt(12)
    v_mfma_f32_16x16x32_bf16 v[28:31], v[188:191], v[100:103], v[28:31]
    ds_read_b64_tr_b16 v[184:185], v210 offset:45056
    ds_read_b64_tr_b16 v[186:187], v210 offset:45568
    s_waitcnt lgkmcnt(12)
    v_mfma_f32_16x16x32_bf16 v[16:19], v[160:163], v[104:107], v[16:19]
    ds_read_b64_tr_b16 v[188:189], v211 offset:45056
    ds_read_b64_tr_b16 v[190:191], v211 offset:45568
    v_mfma_f32_16x16x32_bf16 v[32:35], v[160:163], v[56:59], v[32:35]
    s_add_u32 s86, s40, 4096
    s_cmp_eq_u32 s86, 0xe000
    s_cselect_b32 s41, 0, s86
    s_waitcnt lgkmcnt(12)
    v_mfma_f32_16x16x32_bf16 v[20:23], v[164:167], v[104:107], v[20:23]
    ds_read_b64_tr_b16 v[160:161], v208 offset:49152
    ds_read_b64_tr_b16 v[162:163], v208 offset:49664
    s_waitcnt lgkmcnt(12)
    v_mfma_f32_16x16x32_bf16 v[24:27], v[168:171], v[104:107], v[24:27]
    ds_read_b64_tr_b16 v[164:165], v209 offset:49152
    ds_read_b64_tr_b16 v[166:167], v209 offset:49664
    s_waitcnt lgkmcnt(12)
    v_mfma_f32_16x16x32_bf16 v[28:31], v[172:175], v[104:107], v[28:31]
    ds_read_b64_tr_b16 v[168:169], v210 offset:49152
    ds_read_b64_tr_b16 v[170:171], v210 offset:49664
    s_waitcnt lgkmcnt(12)
    v_mfma_f32_16x16x32_bf16 v[16:19], v[176:179], v[108:111], v[16:19]
    ds_read_b64_tr_b16 v[172:173], v211 offset:49152
    ds_read_b64_tr_b16 v[174:175], v211 offset:49664
    v_mfma_f32_16x16x32_bf16 v[32:35], v[176:179], v[56:59], v[32:35]
    s_add_u32 s86, s41, 4096
    s_cmp_eq_u32 s86, 0xe000
    s_cselect_b32 s42, 0, s86
    s_waitcnt lgkmcnt(12)
    v_mfma_f32_16x16x32_bf16 v[20:23], v[180:183], v[108:111], v[20:23]
    ds_read_b64_tr_b16 v[176:177], v208 offset:53248
    ds_read_b64_tr_b16 v[178:179], v208 offset:53760
    s_waitcnt lgkmcnt(12)
    v_mfma_f32_16x16x32_bf16 v[24:27], v[184:187], v[108:111], v[24:27]
    ds_read_b64_tr_b16 v[180:181], v209 offset:53248
    ds_read_b64_tr_b16 v[182:183], v209 offset:53760
    s_waitcnt lgkmcnt(12)
    v_mfma_f32_16x16x32_bf16 v[28:31], v[188:191], v[108:111], v[28:31]
    ds_read_b64_tr_b16 v[184:185], v210 offset:53248
    ds_read_b64_tr_b16 v[186:187], v210 offset:53760
    s_waitcnt lgkmcnt(12)
    v_mfma_f32_16x16x32_bf16 v[16:19], v[160:163], v[112:115], v[16:19]
    ds_read_b64_tr_b16 v[188:189], v211 offset:53248
    ds_read_b64_tr_b16 v[190:191], v211 offset:53760
    v_mfma_f32_16x16x32_bf16 v[32:35], v[160:163], v[56:59], v[32:35]
    s_add_u32 s86, s42, 4096
    s_cmp_eq_u32 s86, 0xe000
    s_cselect_b32 s43, 0, s86
    s_waitcnt lgkmcnt(12)
    v_mfma_f32_16x16x32_bf16 v[20:23], v[164:167], v[112:115], v[20:23]
    ds_read_b64_tr_b16 v[160:161], v208 offset:57344
    ds_read_b64_tr_b16 v[162:163], v208 offset:57856
    s_waitcnt lgkmcnt(12)
    v_mfma_f32_16x16x32_bf16 v[24:27], v[168:171], v[112:115], v[24:27]
    ds_read_b64_tr_b16 v[164:165], v209 offset:57344
    ds_read_b64_tr_b16 v[166:167], v209 offset:57856
    s_waitcnt lgkmcnt(12)
    v_mfma_f32_16x16x32_bf16 v[28:31], v[172:175], v[112:115], v[28:31]
    ds_read_b64_tr_b16 v[168:169], v210 offset:57344
    ds_read_b64_tr_b16 v[170:171], v210 offset:57856
    s_waitcnt lgkmcnt(12)
    v_mfma_f32_16x16x32_bf16 v[16:19], v[176:179], v[116:119], v[16:19]
    ds_read_b64_tr_b16 v[172:173], v211 offset:57344
    ds_read_b64_tr_b16 v[174:175], v211 offset:57856
    v_mfma_f32_16x16x32_bf16 v[32:35], v[176:179], v[56:59], v[32:35]
    s_add_u32 s86, s43, 4096
    s_cmp_eq_u32 s86, 0xe000
    s_cselect_b32 s44, 0, s86
    s_waitcnt lgkmcnt(12)
    v_mfma_f32_16x16x32_bf16 v[20:23], v[180:183], v[116:119], v[20:23]
    ds_read_b64_tr_b16 v[176:177], v208 offset:61440
    ds_read_b64_tr_b16 v[178:179], v208 offset:61952
    s_waitcnt lgkmcnt(12)
    v_mfma_f32_16x16x32_bf16 v[24:27], v[184:187], v[116:119], v[24:27]
    ds_read_b64_tr_b16 v[180:181], v209 offset:61440
    ds_read_b64_tr_b16 v[182:183], v209 offset:61952
    buffer_load_dword v14, v223, s[20:23], 0 offen sc1
    s_waitcnt lgkmcnt(12)
    v_mfma_f32_16x16x32_bf16 v[28:31], v[188:191], v[116:119], v[28:31]
    ds_read_b64_tr_b16 v[184:185], v210 offset:61440
    ds_read_b64_tr_b16 v[186:187], v210 offset:61952
    s_waitcnt lgkmcnt(12)
    v_mfma_f32_16x16x32_bf16 v[16:19], v[160:163], v[120:123], v[16:19]
    ds_read_b64_tr_b16 v[188:189], v211 offset:61440
    ds_read_b64_tr_b16 v[190:191], v211 offset:61952
    v_mfma_f32_16x16x32_bf16 v[32:35], v[160:163], v[56:59], v[32:35]
    s_add_u32 s86, s44, 4096
    s_cmp_eq_u32 s86, 0xe000
    s_cselect_b32 s45, 0, s86
    s_waitcnt lgkmcnt(12)
    v_mfma_f32_16x16x32_bf16 v[20:23], v[164:167], v[120:123], v[20:23]
    s_waitcnt lgkmcnt(10)
    v_mfma_f32_16x16x32_bf16 v[24:27], v[168:171], v[120:123], v[24:27]
    s_waitcnt lgkmcnt(8)
    v_mfma_f32_16x16x32_bf16 v[28:31], v[172:175], v[120:123], v[28:31]
    s_waitcnt lgkmcnt(6)
    v_mfma_f32_16x16x32_bf16 v[16:19], v[176:179], v[124:127], v[16:19]
    v_mfma_f32_16x16x32_bf16 v[32:35], v[176:179], v[56:59], v[32:35]
    s_add_u32 s86, s45, 4096
    s_cmp_eq_u32 s86, 0xe000
    s_cselect_b32 s46, 0, s86
    s_waitcnt lgkmcnt(4)
    v_mfma_f32_16x16x32_bf16 v[20:23], v[180:183], v[124:127], v[20:23]
    s_waitcnt lgkmcnt(2)
    v_mfma_f32_16x16x32_bf16 v[24:27], v[184:187], v[124:127], v[24:27]
    s_waitcnt lgkmcnt(0)
    v_mfma_f32_16x16x32_bf16 v[28:31], v[188:191], v[124:127], v[28:31]
    ds_write_b128 v216, v[32:35]
    s_add_u32 s86, s46, 4096
    s_cmp_eq_u32 s86, 0xe000
    s_cselect_b32 s47, 0, s86
    s_add_u32 s86, s47, 4096
    s_cmp_eq_u32 s86, 0xe000
    s_cselect_b32 s48, 0, s86
    s_add_u32 s86, s48, 4096
    s_cmp_eq_u32 s86, 0xe000
    s_cselect_b32 s49, 0, s86
    s_add_u32 s86, s49, 4096
    s_cmp_eq_u32 s86, 0xe000
    s_cselect_b32 s50, 0, s86
    s_add_u32 s86, s50, 4096
    s_cmp_eq_u32 s86, 0xe000
    s_cselect_b32 s51, 0, s86
    s_add_u32 s86, s51, 4096
    s_cmp_eq_u32 s86, 0xe000
    s_cselect_b32 s52, 0, s86
    s_add_u32 s86, s52, 4096
    s_cmp_eq_u32 s86, 0xe000
    s_cselect_b32 s53, 0, s86
    s_waitcnt lgkmcnt(0)
    s_barrier
    ds_read_b128 v[36:39], v217
    ds_read_b128 v[40:43], v218
    ds_read_b128 v[44:47], v219
    s_waitcnt vmcnt(0)
    v_cmp_ne_u32 vcc, s39, v14
    s_nop 0
    s_cmp_eq_u64 vcc, 0
    s_cbranch_scc0 L_kvslow
L_kvok:
    s_mul_i32 s54, s36, 33792
    s_lshr_b32 m0, s54, 1
    s_add_u32 m0, m0, 67584
    s_nop 0
    buffer_load_dwordx4 v8, s[24:27], s54 offen offset:0 sc1 lds
    buffer_load_dwordx4 v8, s[24:27], s54 offen offset:1024 sc1 lds
    buffer_load_dwordx4 v8, s[24:27], s54 offen offset:2048 sc1 lds
    buffer_load_dwordx4 v8, s[24:27], s54 offen offset:3072 sc1 lds
    s_add_u32 m0, m0, 4096
    s_add_u32 s54, s54, 4096
    buffer_load_dwordx4 v8, s[24:27], s54 offen offset:0 sc1 lds
    v_fma_f32 v16, v53, v32, v16
    v_fma_f32 v17, v53, v33, v17
    v_fma_f32 v18, v53, v34, v18
    v_fma_f32 v19, v53, v35, v19
    v_mul_f32 v16, v16, v55
    v_mul_f32 v17, v17, v55
    v_mul_f32 v18, v18, v55
    v_mul_f32 v19, v19, v55
    v_cvt_pk_bf16_f32 v16, v16, v17
    v_cvt_pk_bf16_f32 v17, v18, v19
    ds_write_b64 v212, v[16:17]
    s_waitcnt lgkmcnt(3)
    v_fma_f32 v20, v53, v36, v20
    v_fma_f32 v21, v53, v37, v21
    v_fma_f32 v22, v53, v38, v22
    v_fma_f32 v23, v53, v39, v23
    v_mul_f32 v20, v20, v55
    v_mul_f32 v21, v21, v55
    v_mul_f32 v22, v22, v55
    v_mul_f32 v23, v23, v55
    v_cvt_pk_bf16_f32 v20, v20, v21
    v_cvt_pk_bf16_f32 v21, v22, v23
    ds_write_b64 v213, v[20:21]
    s_waitcnt lgkmcnt(3)
    v_fma_f32 v24, v53, v40, v24
    v_fma_f32 v25, v53, v41, v25
    v_fma_f32 v26, v53, v42, v26
    v_fma_f32 v27, v53, v43, v27
    v_mul_f32 v24, v24, v55
    v_mul_f32 v25, v25, v55
    v_mul_f32 v26, v26, v55
    v_mul_f32 v27, v27, v55
    v_cvt_pk_bf16_f32 v24, v24, v25
    v_cvt_pk_bf16_f32 v25, v26, v27
    ds_write_b64 v214, v[24:25]
    s_waitcnt lgkmcnt(3)
    v_fma_f32 v28, v53, v44, v28
    v_fma_f32 v29, v53, v45, v29
    v_fma_f32 v30, v53, v46, v30
    v_fma_f32 v31, v53, v47, v31
    v_mul_f32 v28, v28, v55
    v_mul_f32 v29, v29, v55
    v_mul_f32 v30, v30, v55
    v_mul_f32 v31, v31, v55
    v_cvt_pk_bf16_f32 v28, v28, v29
    v_cvt_pk_bf16_f32 v29, v30, v31
    ds_write_b64 v215, v[28:29]
    buffer_load_dwordx4 v8, s[24:27], s54 offen offset:1024 sc1 lds
    buffer_load_dwordx4 v8, s[24:27], s54 offen offset:2048 sc1 lds
    buffer_load_dwordx4 v8, s[24:27], s54 offen offset:3072 sc1 lds
    s_add_u32 m0, m0, 4096
    s_add_u32 s54, s54, 4096
    buffer_load_dwordx4 v8, s[24:27], s54 offen offset:0 sc1 lds
    buffer_load_dwordx4 v8, s[24:27], s54 offen offset:1024 sc1 lds
    buffer_load_dwordx4 v8, s[24:27], s54 offen offset:2048 sc1 lds
    v_mov_b32 v136, s97
    v_mov_b32 v137, s97
    v_mov_b32 v138, s97
    v_mov_b32 v139, s97
    v_pk_mul_f32 v[68:69], 0, 0
    v_pk_mul_f32 v[70:71], 0, 0
    v_pk_mul_f32 v[72:73], 0, 0
    v_pk_mul_f32 v[74:75], 0, 0
    v_pk_mul_f32 v[76:77], 0, 0
    v_pk_mul_f32 v[78:79], 0, 0
    v_pk_mul_f32 v[80:81], 0, 0
    v_pk_mul_f32 v[82:83], 0, 0
    v_pk_mul_f32 v[84:85], 0, 0
    v_pk_mul_f32 v[86:87], 0, 0
    v_pk_mul_f32 v[88:89], 0, 0
    v_pk_mul_f32 v[90:91], 0, 0
    v_pk_mul_f32 v[92:93], 0, 0
    v_pk_mul_f32 v[94:95], 0, 0
    v_pk_mul_f32 v[96:97], 0, 0
    v_pk_mul_f32 v[98:99], 0, 0
    s_lshl_b32 s86, s36, 11
    s_add_u32 s86, s86, 135168
    v_add_u32 v11, s86, v8
    s_lshl_b32 s55, s38, 3
    s_add_u32 s55, s55, s37
    s_lshl_b32 s55, s55, 7
    s_add_u32 s55, s55, 15794176
    v_mov_b32 v10, s84
    s_waitcnt vmcnt(6)
    s_waitcnt lgkmcnt(0)
    s_barrier
    ds_read_b128 v[16:19], v11
    ds_read_b128 v[20:23], v11 offset:1024
    s_mul_i32 s63, s36, 23552
    s_add_u32 s63, s63, 65536
    ds_read_b128 v[24:27], v3 offset:2112
    ds_read_b128 v[28:31], v6 offset:2112
    s_waitcnt lgkmcnt(1)
    v_mfma_f32_32x32x16_bf16 v[36:51], v[24:27], v[16:19], 0
    s_nop 11
    v_exp_f32 v36, v36
    v_exp_f32 v37, v37
    s_waitcnt lgkmcnt(0)
    ds_read_b128 v[32:35], v6 offset:2656
    v_exp_f32 v38, v38
    v_exp_f32 v39, v39
    v_exp_f32 v40, v40
    v_mfma_f32_32x32x16_bf16 v[52:67], v[24:27], v[20:23], 0
    ds_read_b128 v[24:27], v3 offset:4224
    v_exp_f32 v41, v41
    v_exp_f32 v42, v42
    v_exp_f32 v43, v43
    v_exp_f32 v44, v44
    v_exp_f32 v45, v45
    v_smfmac_f32_32x32x32_bf16 v[68:83], v[28:31], v[36:43], v1
    s_waitcnt lgkmcnt(1)
    buffer_load_dwordx4 v8, s[24:27], s54 offen offset:3072 sc1 lds
    v_exp_f32 v46, v46
    v_exp_f32 v47, v47
    v_exp_f32 v48, v48
    v_exp_f32 v49, v49
    v_exp_f32 v50, v50
    v_exp_f32 v51, v51
    v_exp_f32 v52, v52
    v_exp_f32 v53, v53
    v_smfmac_f32_32x32x32_bf16 v[68:83], v[32:35], v[44:51], v1
    s_waitcnt lgkmcnt(0)
    s_add_u32 m0, m0, 4096
    s_add_u32 s54, s54, 4096
    buffer_load_dwordx4 v8, s[24:27], s54 offen offset:0 sc1 lds
    v_exp_f32 v54, v54
    v_exp_f32 v55, v55
    v_exp_f32 v56, v56
    v_mfma_f32_32x32x16_bf16 v[36:51], v[24:27], v[16:19], 0
    buffer_load_dwordx4 v8, s[24:27], s54 offen offset:1024 sc1 lds
    v_exp_f32 v57, v57
    v_exp_f32 v58, v58
    v_exp_f32 v59, v59
    v_exp_f32 v60, v60
    v_exp_f32 v61, v61
    v_smfmac_f32_32x32x32_bf16 v[84:99], v[28:31], v[52:59], v1
    ds_read_b128 v[28:31], v6 offset:4224
    v_exp_f32 v62, v62
    v_exp_f32 v63, v63
    v_exp_f32 v64, v64
    v_exp_f32 v65, v65
    v_exp_f32 v66, v66
    v_exp_f32 v67, v67
    v_exp_f32 v36, v36
    v_exp_f32 v37, v37
    v_smfmac_f32_32x32x32_bf16 v[84:99], v[32:35], v[60:67], v1
    s_waitcnt lgkmcnt(0)
    ds_read_b128 v[32:35], v6 offset:4768
    v_exp_f32 v38, v38
    v_exp_f32 v39, v39
    v_exp_f32 v40, v40
    v_mfma_f32_32x32x16_bf16 v[52:67], v[24:27], v[20:23], 0
    ds_read_b128 v[24:27], v3 offset:19008
    v_exp_f32 v41, v41
    v_exp_f32 v42, v42
    v_exp_f32 v43, v43
    v_exp_f32 v44, v44
    v_exp_f32 v45, v45
    v_smfmac_f32_32x32x32_bf16 v[68:83], v[28:31], v[36:43], v1
    s_waitcnt lgkmcnt(1)
    buffer_load_dwordx4 v8, s[24:27], s54 offen offset:2048 sc1 lds
    v_exp_f32 v46, v46
    v_exp_f32 v47, v47
    v_exp_f32 v48, v48
    v_exp_f32 v49, v49
    v_exp_f32 v50, v50
    v_exp_f32 v51, v51
    v_exp_f32 v52, v52
    v_exp_f32 v53, v53
    v_smfmac_f32_32x32x32_bf16 v[68:83], v[32:35], v[44:51], v1
    s_waitcnt lgkmcnt(0)
    buffer_load_dwordx4 v8, s[24:27], s54 offen offset:3072 sc1 lds
    v_exp_f32 v54, v54
    v_exp_f32 v55, v55
    v_exp_f32 v56, v56
    v_mfma_f32_32x32x16_bf16 v[36:51], v[24:27], v[16:19], 0
    s_add_u32 m0, m0, 3584
    s_add_u32 s54, s54, 3584
    buffer_load_dwordx4 v8, s[24:27], s54 offen offset:0 sc1 lds
    v_exp_f32 v57, v57
    v_exp_f32 v58, v58
    v_exp_f32 v59, v59
    v_exp_f32 v60, v60
    v_exp_f32 v61, v61
    v_smfmac_f32_32x32x32_bf16 v[84:99], v[28:31], v[52:59], v1
    ds_read_b128 v[28:31], v6 offset:19008
    v_exp_f32 v62, v62
    v_exp_f32 v63, v63
    v_exp_f32 v64, v64
    v_exp_f32 v65, v65
    v_exp_f32 v66, v66
    v_exp_f32 v67, v67
    v_exp_f32 v36, v36
    v_exp_f32 v37, v37
    v_smfmac_f32_32x32x32_bf16 v[84:99], v[32:35], v[60:67], v1
    s_waitcnt lgkmcnt(0)
    ds_read_b128 v[32:35], v6 offset:19552
    v_exp_f32 v38, v38
    v_exp_f32 v39, v39
    v_exp_f32 v40, v40
    v_mfma_f32_32x32x16_bf16 v[52:67], v[24:27], v[20:23], 0
    ds_read_b128 v[24:27], v3 offset:21120
    v_exp_f32 v41, v41
    v_exp_f32 v42, v42
    v_exp_f32 v43, v43
    v_exp_f32 v44, v44
    v_exp_f32 v45, v45
    v_smfmac_f32_32x32x32_bf16 v[68:83], v[28:31], v[36:43], v1
    s_waitcnt lgkmcnt(1)
    s_mov_b32 s94, 0x05040100
    s_mov_b32 s95, 0x07060302
    v_perm_b32 v240, v225, v224, s94
    v_perm_b32 v241, v227, v226, s94
    v_perm_b32 v242, v229, v228, s94
    v_perm_b32 v243, v231, v230, s94
    buffer_store_dwordx4 v[240:243], v206, s[20:23], 0 offen sc1
    s_nop 0
    v_mfma_f32_32x32x16_bf16 v[160:175], v[136:139], v[240:243], 0
    v_exp_f32 v46, v46
    v_exp_f32 v47, v47
    v_exp_f32 v48, v48
    v_exp_f32 v49, v49
    v_exp_f32 v50, v50
    v_exp_f32 v51, v51
    v_exp_f32 v52, v52
    v_exp_f32 v53, v53
    v_smfmac_f32_32x32x32_bf16 v[68:83], v[32:35], v[44:51], v1
    s_waitcnt lgkmcnt(0)
    v_perm_b32 v244, v225, v224, s95
    v_perm_b32 v245, v227, v226, s95
    v_perm_b32 v246, v229, v228, s95
    v_perm_b32 v247, v231, v230, s95
    buffer_store_dwordx4 v[244:247], v206, s[20:23], s81 offen sc1
    s_nop 0
    v_mfma_f32_32x32x16_bf16 v[176:191], v[136:139], v[244:247], 0
    v_exp_f32 v54, v54
    v_exp_f32 v55, v55
    v_exp_f32 v56, v56
    v_mfma_f32_32x32x16_bf16 v[36:51], v[24:27], v[16:19], 0
    v_perm_b32 v248, v233, v232, s94
    v_perm_b32 v249, v235, v234, s94
    v_perm_b32 v250, v237, v236, s94
    v_perm_b32 v251, v239, v238, s94
    buffer_store_dwordx4 v[248:251], v206, s[20:23], s80 offen sc1
    s_nop 0
    v_mfma_f32_32x32x16_bf16 v[160:175], v[136:139], v[248:251], v[160:175]
    v_exp_f32 v57, v57
    v_exp_f32 v58, v58
    v_exp_f32 v59, v59
    v_exp_f32 v60, v60
    v_exp_f32 v61, v61
    v_smfmac_f32_32x32x32_bf16 v[84:99], v[28:31], v[52:59], v1
    ds_read_b128 v[28:31], v6 offset:21120
    v_exp_f32 v62, v62
    v_exp_f32 v63, v63
    v_exp_f32 v64, v64
    v_exp_f32 v65, v65
    v_exp_f32 v66, v66
    v_exp_f32 v67, v67
    v_exp_f32 v36, v36
    v_exp_f32 v37, v37
    v_smfmac_f32_32x32x32_bf16 v[84:99], v[32:35], v[60:67], v1
    s_waitcnt lgkmcnt(0)
    ds_read_b128 v[32:35], v6 offset:21664
    v_exp_f32 v38, v38
    v_exp_f32 v39, v39
    v_exp_f32 v40, v40
    v_mfma_f32_32x32x16_bf16 v[52:67], v[24:27], v[20:23], 0
    ds_read_b128 v[24:27], v3 offset:35904
    v_exp_f32 v41, v41
    v_exp_f32 v42, v42
    v_exp_f32 v43, v43
    v_exp_f32 v44, v44
    v_exp_f32 v45, v45
    v_smfmac_f32_32x32x32_bf16 v[68:83], v[28:31], v[36:43], v1
    s_waitcnt lgkmcnt(1)
    v_perm_b32 v252, v233, v232, s95
    v_perm_b32 v253, v235, v234, s95
    v_perm_b32 v254, v237, v236, s95
    v_perm_b32 v255, v239, v238, s95
    buffer_store_dwordx4 v[252:255], v206, s[20:23], s82 offen sc1
    s_nop 0
    v_mfma_f32_32x32x16_bf16 v[176:191], v[136:139], v[252:255], v[176:191]
    v_exp_f32 v46, v46
    v_exp_f32 v47, v47
    v_exp_f32 v48, v48
    v_exp_f32 v49, v49
    v_exp_f32 v50, v50
    v_exp_f32 v51, v51
    v_exp_f32 v52, v52
    v_exp_f32 v53, v53
    v_smfmac_f32_32x32x32_bf16 v[68:83], v[32:35], v[44:51], v1
    s_waitcnt lgkmcnt(0)
    s_nop 1
    v_permlane32_swap_b32 v160, v176
    buffer_store_dword v160, v207, s[20:23], 0 offen sc1
    v_exp_f32 v54, v54
    v_exp_f32 v55, v55
    v_exp_f32 v56, v56
    v_mfma_f32_32x32x16_bf16 v[36:51], v[24:27], v[16:19], 0
    v_exp_f32 v57, v57
    v_exp_f32 v58, v58
    v_exp_f32 v59, v59
    v_exp_f32 v60, v60
    v_exp_f32 v61, v61
    v_smfmac_f32_32x32x32_bf16 v[84:99], v[28:31], v[52:59], v1
    ds_read_b128 v[28:31], v6 offset:35904
    v_exp_f32 v62, v62
    v_exp_f32 v63, v63
    v_exp_f32 v64, v64
    v_exp_f32 v65, v65
    v_exp_f32 v66, v66
    v_exp_f32 v67, v67
    v_exp_f32 v36, v36
    v_exp_f32 v37, v37
    v_smfmac_f32_32x32x32_bf16 v[84:99], v[32:35], v[60:67], v1
    s_waitcnt lgkmcnt(0)
    ds_read_b128 v[32:35], v6 offset:36448
    v_exp_f32 v38, v38
    v_exp_f32 v39, v39
    v_exp_f32 v40, v40
    v_mfma_f32_32x32x16_bf16 v[52:67], v[24:27], v[20:23], 0
    ds_read_b128 v[24:27], v3 offset:38016
    v_exp_f32 v41, v41
    v_exp_f32 v42, v42
    v_exp_f32 v43, v43
    v_exp_f32 v44, v44
    v_exp_f32 v45, v45
    v_smfmac_f32_32x32x32_bf16 v[68:83], v[28:31], v[36:43], v1
    s_waitcnt lgkmcnt(1)
    v_exp_f32 v46, v46
    v_exp_f32 v47, v47
    v_exp_f32 v48, v48
    v_exp_f32 v49, v49
    v_exp_f32 v50, v50
    v_exp_f32 v51, v51
    v_exp_f32 v52, v52
    v_exp_f32 v53, v53
    v_smfmac_f32_32x32x32_bf16 v[68:83], v[32:35], v[44:51], v1
    s_waitcnt lgkmcnt(0)
    v_exp_f32 v54, v54
    v_exp_f32 v55, v55
    v_exp_f32 v56, v56
    v_mfma_f32_32x32x16_bf16 v[36:51], v[24:27], v[16:19], 0
    v_exp_f32 v57, v57
    v_exp_f32 v58, v58
    v_exp_f32 v59, v59
    v_exp_f32 v60, v60
    v_exp_f32 v61, v61
    v_smfmac_f32_32x32x32_bf16 v[84:99], v[28:31], v[52:59], v1
    ds_read_b128 v[28:31], v6 offset:38016
    v_exp_f32 v62, v62
    v_exp_f32 v63, v63
    v_exp_f32 v64, v64
    v_exp_f32 v65, v65
    v_exp_f32 v66, v66
    v_exp_f32 v67, v67
    v_exp_f32 v36, v36
    v_exp_f32 v37, v37
    v_smfmac_f32_32x32x32_bf16 v[84:99], v[32:35], v[60:67], v1
    s_waitcnt lgkmcnt(0)
    ds_read_b128 v[32:35], v6 offset:38560
    v_exp_f32 v38, v38
    v_exp_f32 v39, v39
    v_exp_f32 v40, v40
    v_mfma_f32_32x32x16_bf16 v[52:67], v[24:27], v[20:23], 0
    ds_read_b128 v[24:27], v3 offset:52800
    v_exp_f32 v41, v41
    v_exp_f32 v42, v42
    v_exp_f32 v43, v43
    v_exp_f32 v44, v44
    v_exp_f32 v45, v45
    v_smfmac_f32_32x32x32_bf16 v[68:83], v[28:31], v[36:43], v1
    s_waitcnt lgkmcnt(1)
    v_exp_f32 v46, v46
    v_exp_f32 v47, v47
    v_exp_f32 v48, v48
    v_exp_f32 v49, v49
    v_exp_f32 v50, v50
    v_exp_f32 v51, v51
    v_exp_f32 v52, v52
    v_exp_f32 v53, v53
    v_smfmac_f32_32x32x32_bf16 v[68:83], v[32:35], v[44:51], v1
    s_waitcnt lgkmcnt(0)
    v_exp_f32 v54, v54
    v_exp_f32 v55, v55
    v_exp_f32 v56, v56
    v_mfma_f32_32x32x16_bf16 v[36:51], v[24:27], v[16:19], 0
    v_exp_f32 v57, v57
    v_exp_f32 v58, v58
    v_exp_f32 v59, v59
    v_exp_f32 v60, v60
    v_exp_f32 v61, v61
    v_smfmac_f32_32x32x32_bf16 v[84:99], v[28:31], v[52:59], v1
    ds_read_b128 v[28:31], v6 offset:52800
    v_exp_f32 v62, v62
    v_exp_f32 v63, v63
    v_exp_f32 v64, v64
    v_exp_f32 v65, v65
    v_exp_f32 v66, v66
    v_exp_f32 v67, v67
    v_exp_f32 v36, v36
    v_exp_f32 v37, v37
    v_smfmac_f32_32x32x32_bf16 v[84:99], v[32:35], v[60:67], v1
    s_waitcnt lgkmcnt(0)
    ds_read_b128 v[32:35], v6 offset:53344
    v_exp_f32 v38, v38
    v_exp_f32 v39, v39
    v_exp_f32 v40, v40
    v_mfma_f32_32x32x16_bf16 v[52:67], v[24:27], v[20:23], 0
    ds_read_b128 v[24:27], v3 offset:54912
    v_exp_f32 v41, v41
    v_exp_f32 v42, v42
    v_exp_f32 v43, v43
    v_exp_f32 v44, v44
    v_exp_f32 v45, v45
    v_smfmac_f32_32x32x32_bf16 v[68:83], v[28:31], v[36:43], v1
    s_waitcnt lgkmcnt(1)
    v_exp_f32 v46, v46
    v_exp_f32 v47, v47
    v_exp_f32 v48, v48
    v_exp_f32 v49, v49
    v_exp_f32 v50, v50
    v_exp_f32 v51, v51
    v_exp_f32 v52, v52
    v_exp_f32 v53, v53
    v_smfmac_f32_32x32x32_bf16 v[68:83], v[32:35], v[44:51], v1
    s_waitcnt lgkmcnt(0)
    v_exp_f32 v54, v54
    v_exp_f32 v55, v55
    v_exp_f32 v56, v56
    v_mfma_f32_32x32x16_bf16 v[36:51], v[24:27], v[16:19], 0
    v_exp_f32 v57, v57
    v_exp_f32 v58, v58
    v_exp_f32 v59, v59
    v_exp_f32 v60, v60
    v_exp_f32 v61, v61
    v_smfmac_f32_32x32x32_bf16 v[84:99], v[28:31], v[52:59], v1
    ds_read_b128 v[28:31], v6 offset:54912
    v_exp_f32 v62, v62
    v_exp_f32 v63, v63
    v_exp_f32 v64, v64
    v_exp_f32 v65, v65
    v_exp_f32 v66, v66
    v_exp_f32 v67, v67
    v_exp_f32 v36, v36
    v_exp_f32 v37, v37
    v_smfmac_f32_32x32x32_bf16 v[84:99], v[32:35], v[60:67], v1
    s_waitcnt lgkmcnt(0)
    ds_read_b128 v[32:35], v6 offset:55456
    v_exp_f32 v38, v38
    v_exp_f32 v39, v39
    v_exp_f32 v40, v40
    v_mfma_f32_32x32x16_bf16 v[52:67], v[24:27], v[20:23], 0
    s_waitcnt vmcnt(5)
    s_barrier
    ds_read_b128 v[24:27], v3 offset:6336
    v_exp_f32 v41, v41
    v_exp_f32 v42, v42
    v_exp_f32 v43, v43
    v_exp_f32 v44, v44
    v_exp_f32 v45, v45
    v_smfmac_f32_32x32x32_bf16 v[68:83], v[28:31], v[36:43], v1
    s_waitcnt lgkmcnt(1)
    v_exp_f32 v46, v46
    v_exp_f32 v47, v47
    v_exp_f32 v48, v48
    v_exp_f32 v49, v49
    v_exp_f32 v50, v50
    v_exp_f32 v51, v51
    v_exp_f32 v52, v52
    v_exp_f32 v53, v53
    v_smfmac_f32_32x32x32_bf16 v[68:83], v[32:35], v[44:51], v1
    s_waitcnt lgkmcnt(0)
    v_exp_f32 v54, v54
    v_exp_f32 v55, v55
    v_exp_f32 v56, v56
    v_mfma_f32_32x32x16_bf16 v[36:51], v[24:27], v[16:19], 0
    v_exp_f32 v57, v57
    v_exp_f32 v58, v58
    v_exp_f32 v59, v59
    v_exp_f32 v60, v60
    v_exp_f32 v61, v61
    v_smfmac_f32_32x32x32_bf16 v[84:99], v[28:31], v[52:59], v1
    ds_read_b128 v[28:31], v6 offset:6336
    v_exp_f32 v62, v62
    v_exp_f32 v63, v63
    v_exp_f32 v64, v64
    v_exp_f32 v65, v65
    v_exp_f32 v66, v66
    v_exp_f32 v67, v67
    v_exp_f32 v36, v36
    v_exp_f32 v37, v37
    v_smfmac_f32_32x32x32_bf16 v[84:99], v[32:35], v[60:67], v1
    s_waitcnt lgkmcnt(0)
    ds_read_b128 v[32:35], v6 offset:6880
    v_exp_f32 v38, v38
    v_exp_f32 v39, v39
    v_exp_f32 v40, v40
    v_mfma_f32_32x32x16_bf16 v[52:67], v[24:27], v[20:23], 0
    ds_read_b128 v[24:27], v3 offset:8448
    v_exp_f32 v41, v41
    v_exp_f32 v42, v42
    v_exp_f32 v43, v43
    v_exp_f32 v44, v44
    v_exp_f32 v45, v45
    v_smfmac_f32_32x32x32_bf16 v[68:83], v[28:31], v[36:43], v1
    s_waitcnt lgkmcnt(1)
    v_exp_f32 v46, v46
    v_exp_f32 v47, v47
    v_exp_f32 v48, v48
    v_exp_f32 v49, v49
    v_exp_f32 v50, v50
    v_exp_f32 v51, v51
    v_exp_f32 v52, v52
    v_exp_f32 v53, v53
    v_smfmac_f32_32x32x32_bf16 v[68:83], v[32:35], v[44:51], v1
    s_waitcnt lgkmcnt(0)
    v_exp_f32 v54, v54
    v_exp_f32 v55, v55
    v_exp_f32 v56, v56
    v_mfma_f32_32x32x16_bf16 v[36:51], v[24:27], v[16:19], 0
    v_exp_f32 v57, v57
    v_exp_f32 v58, v58
    v_exp_f32 v59, v59
    v_exp_f32 v60, v60
    v_exp_f32 v61, v61
    v_smfmac_f32_32x32x32_bf16 v[84:99], v[28:31], v[52:59], v1
    ds_read_b128 v[28:31], v6 offset:8448
    v_exp_f32 v62, v62
    v_exp_f32 v63, v63
    v_exp_f32 v64, v64
    v_exp_f32 v65, v65
    v_exp_f32 v66, v66
    v_exp_f32 v67, v67
    v_exp_f32 v36, v36
    v_exp_f32 v37, v37
    v_smfmac_f32_32x32x32_bf16 v[84:99], v[32:35], v[60:67], v1
    s_waitcnt lgkmcnt(0)
    ds_read_b128 v[32:35], v6 offset:8992
    v_exp_f32 v38, v38
    v_exp_f32 v39, v39
    v_exp_f32 v40, v40
    v_mfma_f32_32x32x16_bf16 v[52:67], v[24:27], v[20:23], 0
    ds_read_b128 v[24:27], v3 offset:10560
    v_exp_f32 v41, v41
    v_exp_f32 v42, v42
    v_exp_f32 v43, v43
    v_exp_f32 v44, v44
    v_exp_f32 v45, v45
    v_smfmac_f32_32x32x32_bf16 v[68:83], v[28:31], v[36:43], v1
    s_waitcnt lgkmcnt(1)
    v_exp_f32 v46, v46
    v_exp_f32 v47, v47
    v_exp_f32 v48, v48
    v_exp_f32 v49, v49
    v_exp_f32 v50, v50
    v_exp_f32 v51, v51
    v_exp_f32 v52, v52
    v_exp_f32 v53, v53
    v_smfmac_f32_32x32x32_bf16 v[68:83], v[32:35], v[44:51], v1
    s_waitcnt lgkmcnt(0)
    v_exp_f32 v54, v54
    v_exp_f32 v55, v55
    v_exp_f32 v56, v56
    v_mfma_f32_32x32x16_bf16 v[36:51], v[24:27], v[16:19], 0
    v_exp_f32 v57, v57
    v_exp_f32 v58, v58
    v_exp_f32 v59, v59
    v_exp_f32 v60, v60
    v_exp_f32 v61, v61
    v_smfmac_f32_32x32x32_bf16 v[84:99], v[28:31], v[52:59], v1
    ds_read_b128 v[28:31], v6 offset:10560
    v_exp_f32 v62, v62
    v_exp_f32 v63, v63
    v_exp_f32 v64, v64
    v_exp_f32 v65, v65
    v_exp_f32 v66, v66
    v_exp_f32 v67, v67
    v_exp_f32 v36, v36
    v_exp_f32 v37, v37
    v_smfmac_f32_32x32x32_bf16 v[84:99], v[32:35], v[60:67], v1
    s_waitcnt lgkmcnt(0)
    ds_read_b128 v[32:35], v6 offset:11104
    v_exp_f32 v38, v38
    v_exp_f32 v39, v39
    v_exp_f32 v40, v40
    v_mfma_f32_32x32x16_bf16 v[52:67], v[24:27], v[20:23], 0
    ds_read_b128 v[24:27], v3 offset:12672
    v_exp_f32 v41, v41
    v_exp_f32 v42, v42
    v_exp_f32 v43, v43
    v_exp_f32 v44, v44
    v_exp_f32 v45, v45
    v_smfmac_f32_32x32x32_bf16 v[68:83], v[28:31], v[36:43], v1
    s_waitcnt lgkmcnt(1)
    v_exp_f32 v46, v46
    v_exp_f32 v47, v47
    v_exp_f32 v48, v48
    v_exp_f32 v49, v49
    v_exp_f32 v50, v50
    v_exp_f32 v51, v51
    v_exp_f32 v52, v52
    v_exp_f32 v53, v53
    v_smfmac_f32_32x32x32_bf16 v[68:83], v[32:35], v[44:51], v1
    s_waitcnt lgkmcnt(0)
    v_exp_f32 v54, v54
    v_exp_f32 v55, v55
    v_exp_f32 v56, v56
    v_mfma_f32_32x32x16_bf16 v[36:51], v[24:27], v[16:19], 0
    v_exp_f32 v57, v57
    v_exp_f32 v58, v58
    v_exp_f32 v59, v59
    v_exp_f32 v60, v60
    v_exp_f32 v61, v61
    v_smfmac_f32_32x32x32_bf16 v[84:99], v[28:31], v[52:59], v1
    ds_read_b128 v[28:31], v6 offset:12672
    v_exp_f32 v62, v62
    v_exp_f32 v63, v63
    v_exp_f32 v64, v64
    v_exp_f32 v65, v65
    v_exp_f32 v66, v66
    v_exp_f32 v67, v67
    v_exp_f32 v36, v36
    v_exp_f32 v37, v37
    v_smfmac_f32_32x32x32_bf16 v[84:99], v[32:35], v[60:67], v1
    s_waitcnt lgkmcnt(0)
    ds_read_b128 v[32:35], v6 offset:13216
    v_exp_f32 v38, v38
    v_exp_f32 v39, v39
    v_exp_f32 v40, v40
    v_mfma_f32_32x32x16_bf16 v[52:67], v[24:27], v[20:23], 0
    s_waitcnt vmcnt(0)
    s_barrier
    ds_read_b128 v[24:27], v3 offset:14784
    v_exp_f32 v41, v41
    v_exp_f32 v42, v42
    v_exp_f32 v43, v43
    v_exp_f32 v44, v44
    v_exp_f32 v45, v45
    v_smfmac_f32_32x32x32_bf16 v[68:83], v[28:31], v[36:43], v1
    s_waitcnt lgkmcnt(1)
    s_cmp_eq_u32 s36, 0
    s_cselect_b64 exec, 1, 0
    buffer_store_dword v10, off, s[20:23], s55 sc1
    s_mov_b64 exec, -1
    v_exp_f32 v46, v46
    v_exp_f32 v47, v47
    v_exp_f32 v48, v48
    v_exp_f32 v49, v49
    v_exp_f32 v50, v50
    v_exp_f32 v51, v51
    v_exp_f32 v52, v52
    v_exp_f32 v53, v53
    v_smfmac_f32_32x32x32_bf16 v[68:83], v[32:35], v[44:51], v1
    s_waitcnt lgkmcnt(0)
    v_exp_f32 v54, v54
    v_exp_f32 v55, v55
    v_exp_f32 v56, v56
    v_mfma_f32_32x32x16_bf16 v[36:51], v[24:27], v[16:19], 0
    v_exp_f32 v57, v57
    v_exp_f32 v58, v58
    v_exp_f32 v59, v59
    v_exp_f32 v60, v60
    v_exp_f32 v61, v61
    v_smfmac_f32_32x32x32_bf16 v[84:99], v[28:31], v[52:59], v1
    ds_read_b128 v[28:31], v6 offset:14784
    v_exp_f32 v62, v62
    v_exp_f32 v63, v63
    v_exp_f32 v64, v64
    v_exp_f32 v65, v65
    v_exp_f32 v66, v66
    v_exp_f32 v67, v67
    v_exp_f32 v36, v36
    v_exp_f32 v37, v37
    v_smfmac_f32_32x32x32_bf16 v[84:99], v[32:35], v[60:67], v1
    s_waitcnt lgkmcnt(0)
    ds_read_b128 v[32:35], v6 offset:15328
    v_exp_f32 v38, v38
    v_exp_f32 v39, v39
    v_exp_f32 v40, v40
    v_mfma_f32_32x32x16_bf16 v[52:67], v[24:27], v[20:23], 0
    ds_read_b128 v[24:27], v3 offset:16896
    v_exp_f32 v41, v41
    v_exp_f32 v42, v42
    v_exp_f32 v43, v43
    v_exp_f32 v44, v44
    v_exp_f32 v45, v45
    v_smfmac_f32_32x32x32_bf16 v[68:83], v[28:31], v[36:43], v1
    s_waitcnt lgkmcnt(1)
    s_mul_i32 s54, s36, 33792
    s_lshr_b32 m0, s54, 1
    s_add_u32 s54, s54, 16896
    buffer_load_dwordx4 v8, s[24:27], s54 offen offset:0 sc1 lds
    v_exp_f32 v46, v46
    v_exp_f32 v47, v47
    v_exp_f32 v48, v48
    v_exp_f32 v49, v49
    v_exp_f32 v50, v50
    v_exp_f32 v51, v51
    v_exp_f32 v52, v52
    v_exp_f32 v53, v53
    v_smfmac_f32_32x32x32_bf16 v[68:83], v[32:35], v[44:51], v1
    s_waitcnt lgkmcnt(0)
    buffer_load_dwordx4 v8, s[24:27], s54 offen offset:1024 sc1 lds
    v_exp_f32 v54, v54
    v_exp_f32 v55, v55
    v_exp_f32 v56, v56
    v_mfma_f32_32x32x16_bf16 v[36:51], v[24:27], v[16:19], 0
    v_exp_f32 v57, v57
    v_exp_f32 v58, v58
    v_exp_f32 v59, v59
    v_exp_f32 v60, v60
    v_exp_f32 v61, v61
    v_smfmac_f32_32x32x32_bf16 v[84:99], v[28:31], v[52:59], v1
    ds_read_b128 v[28:31], v6 offset:16896
    v_exp_f32 v62, v62
    v_exp_f32 v63, v63
    v_exp_f32 v64, v64
    v_exp_f32 v65, v65
    v_exp_f32 v66, v66
    v_exp_f32 v67, v67
    v_exp_f32 v36, v36
    v_exp_f32 v37, v37
    v_smfmac_f32_32x32x32_bf16 v[84:99], v[32:35], v[60:67], v1
    s_waitcnt lgkmcnt(0)
    ds_read_b128 v[32:35], v6 offset:17440
    v_exp_f32 v38, v38
    v_exp_f32 v39, v39
    v_exp_f32 v40, v40
    v_mfma_f32_32x32x16_bf16 v[52:67], v[24:27], v[20:23], 0
    ds_read_b128 v[24:27], v3 offset:23232
    v_exp_f32 v41, v41
    v_exp_f32 v42, v42
    v_exp_f32 v43, v43
    v_exp_f32 v44, v44
    v_exp_f32 v45, v45
    v_smfmac_f32_32x32x32_bf16 v[68:83], v[28:31], v[36:43], v1
    s_waitcnt lgkmcnt(1)
    buffer_load_dwordx4 v8, s[24:27], s54 offen offset:2048 sc1 lds
    v_exp_f32 v46, v46
    v_exp_f32 v47, v47
    v_exp_f32 v48, v48
    v_exp_f32 v49, v49
    v_exp_f32 v50, v50
    v_exp_f32 v51, v51
    v_exp_f32 v52, v52
    v_exp_f32 v53, v53
    v_smfmac_f32_32x32x32_bf16 v[68:83], v[32:35], v[44:51], v1
    s_waitcnt lgkmcnt(0)
    buffer_load_dwordx4 v8, s[24:27], s54 offen offset:3072 sc1 lds
    v_exp_f32 v54, v54
    v_exp_f32 v55, v55
    v_exp_f32 v56, v56
    v_mfma_f32_32x32x16_bf16 v[36:51], v[24:27], v[16:19], 0
    v_exp_f32 v57, v57
    v_exp_f32 v58, v58
    v_exp_f32 v59, v59
    v_exp_f32 v60, v60
    v_exp_f32 v61, v61
    v_smfmac_f32_32x32x32_bf16 v[84:99], v[28:31], v[52:59], v1
    ds_read_b128 v[28:31], v6 offset:23232
    v_exp_f32 v62, v62
    v_exp_f32 v63, v63
    v_exp_f32 v64, v64
    v_exp_f32 v65, v65
    v_exp_f32 v66, v66
    v_exp_f32 v67, v67
    v_exp_f32 v36, v36
    v_exp_f32 v37, v37
    v_smfmac_f32_32x32x32_bf16 v[84:99], v[32:35], v[60:67], v1
    s_waitcnt lgkmcnt(0)
    ds_read_b128 v[32:35], v6 offset:23776
    v_exp_f32 v38, v38
    v_exp_f32 v39, v39
    v_exp_f32 v40, v40
    v_mfma_f32_32x32x16_bf16 v[52:67], v[24:27], v[20:23], 0
    ds_read_b128 v[24:27], v3 offset:25344
    v_exp_f32 v41, v41
    v_exp_f32 v42, v42
    v_exp_f32 v43, v43
    v_exp_f32 v44, v44
    v_exp_f32 v45, v45
    v_smfmac_f32_32x32x32_bf16 v[68:83], v[28:31], v[36:43], v1
    s_waitcnt lgkmcnt(1)
    s_add_u32 m0, m0, 4096
    s_add_u32 s54, s54, 4096
    buffer_load_dwordx4 v8, s[24:27], s54 offen offset:0 sc1 lds
    v_exp_f32 v46, v46
    v_exp_f32 v47, v47
    v_exp_f32 v48, v48
    v_exp_f32 v49, v49
    v_exp_f32 v50, v50
    v_exp_f32 v51, v51
    v_exp_f32 v52, v52
    v_exp_f32 v53, v53
    v_smfmac_f32_32x32x32_bf16 v[68:83], v[32:35], v[44:51], v1
    s_waitcnt lgkmcnt(0)
    buffer_load_dwordx4 v8, s[24:27], s54 offen offset:1024 sc1 lds
    v_exp_f32 v54, v54
    v_exp_f32 v55, v55
    v_exp_f32 v56, v56
    v_mfma_f32_32x32x16_bf16 v[36:51], v[24:27], v[16:19], 0
    v_exp_f32 v57, v57
    v_exp_f32 v58, v58
    v_exp_f32 v59, v59
    v_exp_f32 v60, v60
    v_exp_f32 v61, v61
    v_smfmac_f32_32x32x32_bf16 v[84:99], v[28:31], v[52:59], v1
    ds_read_b128 v[28:31], v6 offset:25344
    v_exp_f32 v62, v62
    v_exp_f32 v63, v63
    v_exp_f32 v64, v64
    v_exp_f32 v65, v65
    v_exp_f32 v66, v66
    v_exp_f32 v67, v67
    v_exp_f32 v36, v36
    v_exp_f32 v37, v37
    v_smfmac_f32_32x32x32_bf16 v[84:99], v[32:35], v[60:67], v1
    s_waitcnt lgkmcnt(0)
    ds_read_b128 v[32:35], v6 offset:25888
    v_exp_f32 v38, v38
    v_exp_f32 v39, v39
    v_exp_f32 v40, v40
    v_mfma_f32_32x32x16_bf16 v[52:67], v[24:27], v[20:23], 0
    ds_read_b128 v[24:27], v3 offset:27456
    v_exp_f32 v41, v41
    v_exp_f32 v42, v42
    v_exp_f32 v43, v43
    v_exp_f32 v44, v44
    v_exp_f32 v45, v45
    v_smfmac_f32_32x32x32_bf16 v[68:83], v[28:31], v[36:43], v1
    s_waitcnt lgkmcnt(1)
    buffer_load_dword v100, v130, s[20:23], 0 offen sc1
    buffer_load_dwordx4 v8, s[24:27], s54 offen offset:2048 sc1 lds
    v_exp_f32 v46, v46
    v_exp_f32 v47, v47
    v_exp_f32 v48, v48
    v_exp_f32 v49, v49
    v_exp_f32 v50, v50
    v_exp_f32 v51, v51
    v_exp_f32 v52, v52
    v_exp_f32 v53, v53
    v_smfmac_f32_32x32x32_bf16 v[68:83], v[32:35], v[44:51], v1
    s_waitcnt lgkmcnt(0)
    buffer_load_dwordx4 v8, s[24:27], s54 offen offset:3072 sc1 lds
    v_exp_f32 v54, v54
    v_exp_f32 v55, v55
    v_exp_f32 v56, v56
    v_mfma_f32_32x32x16_bf16 v[36:51], v[24:27], v[16:19], 0
    v_exp_f32 v57, v57
    v_exp_f32 v58, v58
    v_exp_f32 v59, v59
    v_exp_f32 v60, v60
    v_exp_f32 v61, v61
    v_smfmac_f32_32x32x32_bf16 v[84:99], v[28:31], v[52:59], v1
    ds_read_b128 v[28:31], v6 offset:27456
    v_exp_f32 v62, v62
    v_exp_f32 v63, v63
    v_exp_f32 v64, v64
    v_exp_f32 v65, v65
    v_exp_f32 v66, v66
    v_exp_f32 v67, v67
    v_exp_f32 v36, v36
    v_exp_f32 v37, v37
    v_smfmac_f32_32x32x32_bf16 v[84:99], v[32:35], v[60:67], v1
    s_waitcnt lgkmcnt(0)
    ds_read_b128 v[32:35], v6 offset:28000
    v_exp_f32 v38, v38
    v_exp_f32 v39, v39
    v_exp_f32 v40, v40
    v_mfma_f32_32x32x16_bf16 v[52:67], v[24:27], v[20:23], 0
    ds_read_b128 v[24:27], v3 offset:29568
    v_exp_f32 v41, v41
    v_exp_f32 v42, v42
    v_exp_f32 v43, v43
    v_exp_f32 v44, v44
    v_exp_f32 v45, v45
    v_smfmac_f32_32x32x32_bf16 v[68:83], v[28:31], v[36:43], v1
    s_waitcnt lgkmcnt(1)
    s_add_u32 m0, m0, 4096
    s_add_u32 s54, s54, 4096
    buffer_load_dwordx4 v8, s[24:27], s54 offen offset:0 sc1 lds
    v_exp_f32 v46, v46
    v_exp_f32 v47, v47
    v_exp_f32 v48, v48
    v_exp_f32 v49, v49
    v_exp_f32 v50, v50
    v_exp_f32 v51, v51
    v_exp_f32 v52, v52
    v_exp_f32 v53, v53
    v_smfmac_f32_32x32x32_bf16 v[68:83], v[32:35], v[44:51], v1
    s_waitcnt lgkmcnt(0)
    buffer_load_dwordx4 v8, s[24:27], s54 offen offset:1024 sc1 lds
    v_exp_f32 v54, v54
    v_exp_f32 v55, v55
    v_exp_f32 v56, v56
    v_mfma_f32_32x32x16_bf16 v[36:51], v[24:27], v[16:19], 0
    v_exp_f32 v57, v57
    v_exp_f32 v58, v58
    v_exp_f32 v59, v59
    v_exp_f32 v60, v60
    v_exp_f32 v61, v61
    v_smfmac_f32_32x32x32_bf16 v[84:99], v[28:31], v[52:59], v1
    ds_read_b128 v[28:31], v6 offset:29568
    v_exp_f32 v62, v62
    v_exp_f32 v63, v63
    v_exp_f32 v64, v64
    v_exp_f32 v65, v65
    v_exp_f32 v66, v66
    v_exp_f32 v67, v67
    v_exp_f32 v36, v36
    v_exp_f32 v37, v37
    v_smfmac_f32_32x32x32_bf16 v[84:99], v[32:35], v[60:67], v1
    s_waitcnt lgkmcnt(0)
    ds_read_b128 v[32:35], v6 offset:30112
    v_exp_f32 v38, v38
    v_exp_f32 v39, v39
    v_exp_f32 v40, v40
    v_mfma_f32_32x32x16_bf16 v[52:67], v[24:27], v[20:23], 0
    ds_read_b128 v[24:27], v3 offset:31680
    v_exp_f32 v41, v41
    v_exp_f32 v42, v42
    v_exp_f32 v43, v43
    v_exp_f32 v44, v44
    v_exp_f32 v45, v45
    v_smfmac_f32_32x32x32_bf16 v[68:83], v[28:31], v[36:43], v1
    s_waitcnt lgkmcnt(1)
    buffer_load_dwordx4 v8, s[24:27], s54 offen offset:2048 sc1 lds
    v_exp_f32 v46, v46
    v_exp_f32 v47, v47
    v_exp_f32 v48, v48
    v_exp_f32 v49, v49
    v_exp_f32 v50, v50
    v_exp_f32 v51, v51
    v_exp_f32 v52, v52
    v_exp_f32 v53, v53
    v_smfmac_f32_32x32x32_bf16 v[68:83], v[32:35], v[44:51], v1
    s_waitcnt lgkmcnt(0)
    buffer_load_dwordx4 v8, s[24:27], s54 offen offset:3072 sc1 lds
    v_exp_f32 v54, v54
    v_exp_f32 v55, v55
    v_exp_f32 v56, v56
    v_mfma_f32_32x32x16_bf16 v[36:51], v[24:27], v[16:19], 0
    v_exp_f32 v57, v57
    v_exp_f32 v58, v58
    v_exp_f32 v59, v59
    v_exp_f32 v60, v60
    v_exp_f32 v61, v61
    v_smfmac_f32_32x32x32_bf16 v[84:99], v[28:31], v[52:59], v1
    ds_read_b128 v[28:31], v6 offset:31680
    v_exp_f32 v62, v62
    v_exp_f32 v63, v63
    v_exp_f32 v64, v64
    v_exp_f32 v65, v65
    v_exp_f32 v66, v66
    v_exp_f32 v67, v67
    v_exp_f32 v36, v36
    v_exp_f32 v37, v37
    v_smfmac_f32_32x32x32_bf16 v[84:99], v[32:35], v[60:67], v1
    s_waitcnt lgkmcnt(0)
    ds_read_b128 v[32:35], v6 offset:32224
    v_exp_f32 v38, v38
    v_exp_f32 v39, v39
    v_exp_f32 v40, v40
    v_mfma_f32_32x32x16_bf16 v[52:67], v[24:27], v[20:23], 0
    ds_read_b128 v[24:27], v3 offset:33792
    v_exp_f32 v41, v41
    v_exp_f32 v42, v42
    v_exp_f32 v43, v43
    v_exp_f32 v44, v44
    v_exp_f32 v45, v45
    v_smfmac_f32_32x32x32_bf16 v[68:83], v[28:31], v[36:43], v1
    s_waitcnt lgkmcnt(1)
    s_add_u32 m0, m0, 4096
    s_add_u32 s54, s54, 4096
    buffer_load_dwordx4 v8, s[24:27], s54 offen offset:0 sc1 lds
    v_exp_f32 v46, v46
    v_exp_f32 v47, v47
    v_exp_f32 v48, v48
    v_exp_f32 v49, v49
    v_exp_f32 v50, v50
    v_exp_f32 v51, v51
    v_exp_f32 v52, v52
    v_exp_f32 v53, v53
    v_smfmac_f32_32x32x32_bf16 v[68:83], v[32:35], v[44:51], v1
    s_waitcnt lgkmcnt(0)
    s_waitcnt vmcnt(7)
    v_and_b32 v100, -16, v100
    v_cmp_ne_u32 vcc, s39, v100
    s_nop 0
    s_cmp_eq_u64 vcc, 0
    s_cbranch_scc0 L_wfslow
L_wfok:
    buffer_load_dwordx4 v8, s[24:27], s54 offen offset:1024 sc1 lds
    v_exp_f32 v54, v54
    v_exp_f32 v55, v55
    v_exp_f32 v56, v56
    v_mfma_f32_32x32x16_bf16 v[36:51], v[24:27], v[16:19], 0
    s_barrier
    buffer_load_dword v116, v131, s[20:23], 0 offen sc1
    v_exp_f32 v57, v57
    v_exp_f32 v58, v58
    v_exp_f32 v59, v59
    v_exp_f32 v60, v60
    v_exp_f32 v61, v61
    v_smfmac_f32_32x32x32_bf16 v[84:99], v[28:31], v[52:59], v1
    ds_read_b128 v[28:31], v6 offset:33792
    v_exp_f32 v62, v62
    v_exp_f32 v63, v63
    v_exp_f32 v64, v64
    v_exp_f32 v65, v65
    v_exp_f32 v66, v66
    v_exp_f32 v67, v67
    v_exp_f32 v36, v36
    v_exp_f32 v37, v37
    v_smfmac_f32_32x32x32_bf16 v[84:99], v[32:35], v[60:67], v1
    s_waitcnt lgkmcnt(0)
    ds_read_b128 v[32:35], v6 offset:34336
    v_exp_f32 v38, v38
    v_exp_f32 v39, v39
    v_exp_f32 v40, v40
    v_mfma_f32_32x32x16_bf16 v[52:67], v[24:27], v[20:23], 0
    ds_read_b128 v[24:27], v3 offset:40128
    v_exp_f32 v41, v41
    v_exp_f32 v42, v42
    v_exp_f32 v43, v43
    v_exp_f32 v44, v44
    v_exp_f32 v45, v45
    v_smfmac_f32_32x32x32_bf16 v[68:83], v[28:31], v[36:43], v1
    s_waitcnt lgkmcnt(1)
    buffer_load_dwordx4 v8, s[24:27], s54 offen offset:2048 sc1 lds
    v_exp_f32 v46, v46
    v_exp_f32 v47, v47
    v_exp_f32 v48, v48
    v_exp_f32 v49, v49
    v_exp_f32 v50, v50
    v_exp_f32 v51, v51
    v_exp_f32 v52, v52
    v_exp_f32 v53, v53
    v_smfmac_f32_32x32x32_bf16 v[68:83], v[32:35], v[44:51], v1
    s_waitcnt lgkmcnt(0)
    buffer_load_dwordx4 v8, s[24:27], s54 offen offset:3072 sc1 lds
    v_exp_f32 v54, v54
    v_exp_f32 v55, v55
    v_exp_f32 v56, v56
    v_mfma_f32_32x32x16_bf16 v[36:51], v[24:27], v[16:19], 0
    buffer_load_dwordx4 v[160:163], v156, s[20:23], s72 offen offset:0 sc1
    v_exp_f32 v57, v57
    v_exp_f32 v58, v58
    v_exp_f32 v59, v59
    v_exp_f32 v60, v60
    v_exp_f32 v61, v61
    v_smfmac_f32_32x32x32_bf16 v[84:99], v[28:31], v[52:59], v1
    ds_read_b128 v[28:31], v6 offset:40128
    v_exp_f32 v62, v62
    v_exp_f32 v63, v63
    v_exp_f32 v64, v64
    v_exp_f32 v65, v65
    v_exp_f32 v66, v66
    v_exp_f32 v67, v67
    v_exp_f32 v36, v36
    v_exp_f32 v37, v37
    v_smfmac_f32_32x32x32_bf16 v[84:99], v[32:35], v[60:67], v1
    s_waitcnt lgkmcnt(0)
    ds_read_b128 v[32:35], v6 offset:40672
    v_exp_f32 v38, v38
    v_exp_f32 v39, v39
    v_exp_f32 v40, v40
    v_mfma_f32_32x32x16_bf16 v[52:67], v[24:27], v[20:23], 0
    ds_read_b128 v[24:27], v3 offset:42240
    v_exp_f32 v41, v41
    v_exp_f32 v42, v42
    v_exp_f32 v43, v43
    v_exp_f32 v44, v44
    v_exp_f32 v45, v45
    v_smfmac_f32_32x32x32_bf16 v[68:83], v[28:31], v[36:43], v1
    s_waitcnt lgkmcnt(1)
    s_add_u32 m0, m0, 3584
    s_add_u32 s54, s54, 3584
    buffer_load_dwordx4 v8, s[24:27], s54 offen offset:0 sc1 lds
    v_exp_f32 v46, v46
    v_exp_f32 v47, v47
    v_exp_f32 v48, v48
    v_exp_f32 v49, v49
    v_exp_f32 v50, v50
    v_exp_f32 v51, v51
    v_exp_f32 v52, v52
    v_exp_f32 v53, v53
    v_smfmac_f32_32x32x32_bf16 v[68:83], v[32:35], v[44:51], v1
    s_waitcnt lgkmcnt(0)
    buffer_load_dwordx4 v[144:147], v155, s[4:7], 0 offen
    v_exp_f32 v54, v54
    v_exp_f32 v55, v55
    v_exp_f32 v56, v56
    v_mfma_f32_32x32x16_bf16 v[36:51], v[24:27], v[16:19], 0
    buffer_load_dwordx4 v[164:167], v156, s[20:23], s72 offen offset:1024 sc1
    v_exp_f32 v57, v57
    v_exp_f32 v58, v58
    v_exp_f32 v59, v59
    v_exp_f32 v60, v60
    v_exp_f32 v61, v61
    v_smfmac_f32_32x32x32_bf16 v[84:99], v[28:31], v[52:59], v1
    ds_read_b128 v[28:31], v6 offset:42240
    v_exp_f32 v62, v62
    v_exp_f32 v63, v63
    v_exp_f32 v64, v64
    v_exp_f32 v65, v65
    v_exp_f32 v66, v66
    v_exp_f32 v67, v67
    v_exp_f32 v36, v36
    v_exp_f32 v37, v37
    v_smfmac_f32_32x32x32_bf16 v[84:99], v[32:35], v[60:67], v1
    s_waitcnt lgkmcnt(0)
    ds_read_b128 v[32:35], v6 offset:42784
    v_exp_f32 v38, v38
    v_exp_f32 v39, v39
    v_exp_f32 v40, v40
    v_mfma_f32_32x32x16_bf16 v[52:67], v[24:27], v[20:23], 0
    ds_read_b128 v[24:27], v3 offset:44352
    v_exp_f32 v41, v41
    v_exp_f32 v42, v42
    v_exp_f32 v43, v43
    v_exp_f32 v44, v44
    v_exp_f32 v45, v45
    v_smfmac_f32_32x32x32_bf16 v[68:83], v[28:31], v[36:43], v1
    s_waitcnt lgkmcnt(1)
    buffer_load_dwordx4 v[148:151], v155, s[4:7], s79 offen
    v_exp_f32 v46, v46
    v_exp_f32 v47, v47
    v_exp_f32 v48, v48
    v_exp_f32 v49, v49
    v_exp_f32 v50, v50
    v_exp_f32 v51, v51
    v_exp_f32 v52, v52
    v_exp_f32 v53, v53
    v_smfmac_f32_32x32x32_bf16 v[68:83], v[32:35], v[44:51], v1
    s_waitcnt lgkmcnt(0)
    buffer_load_dwordx4 v[168:171], v156, s[20:23], s72 offen offset:2048 sc1
    v_exp_f32 v54, v54
    v_exp_f32 v55, v55
    v_exp_f32 v56, v56
    v_mfma_f32_32x32x16_bf16 v[36:51], v[24:27], v[16:19], 0
    buffer_load_dwordx4 v[172:175], v156, s[20:23], s72 offen offset:3072 sc1
    v_exp_f32 v57, v57
    v_exp_f32 v58, v58
    v_exp_f32 v59, v59
    v_exp_f32 v60, v60
    v_exp_f32 v61, v61
    v_smfmac_f32_32x32x32_bf16 v[84:99], v[28:31], v[52:59], v1
    ds_read_b128 v[28:31], v6 offset:44352
    v_exp_f32 v62, v62
    v_exp_f32 v63, v63
    v_exp_f32 v64, v64
    v_exp_f32 v65, v65
    v_exp_f32 v66, v66
    v_exp_f32 v67, v67
    v_exp_f32 v36, v36
    v_exp_f32 v37, v37
    v_smfmac_f32_32x32x32_bf16 v[84:99], v[32:35], v[60:67], v1
    s_waitcnt lgkmcnt(0)
    ds_read_b128 v[32:35], v6 offset:44896
    v_exp_f32 v38, v38
    v_exp_f32 v39, v39
    v_exp_f32 v40, v40
    v_mfma_f32_32x32x16_bf16 v[52:67], v[24:27], v[20:23], 0
    ds_read_b128 v[24:27], v3 offset:46464
    v_exp_f32 v41, v41
    v_exp_f32 v42, v42
    v_exp_f32 v43, v43
    v_exp_f32 v44, v44
    v_exp_f32 v45, v45
    v_smfmac_f32_32x32x32_bf16 v[68:83], v[28:31], v[36:43], v1
    s_waitcnt lgkmcnt(1)
    buffer_load_dwordx4 v[176:179], v156, s[20:23], s73 offen offset:0 sc1
    v_exp_f32 v46, v46
    v_exp_f32 v47, v47
    v_exp_f32 v48, v48
    v_exp_f32 v49, v49
    v_exp_f32 v50, v50
    v_exp_f32 v51, v51
    v_exp_f32 v52, v52
    v_exp_f32 v53, v53
    v_smfmac_f32_32x32x32_bf16 v[68:83], v[32:35], v[44:51], v1
    s_waitcnt lgkmcnt(0)
    buffer_load_dwordx4 v[180:183], v156, s[20:23], s73 offen offset:1024 sc1
    v_exp_f32 v54, v54
    v_exp_f32 v55, v55
    v_exp_f32 v56, v56
    v_mfma_f32_32x32x16_bf16 v[36:51], v[24:27], v[16:19], 0
    s_waitcnt vmcnt(11)
    v_cmp_ne_u32 vcc, s84, v116
    s_nop 0
    s_cmp_eq_u64 vcc, 0
    s_cselect_b32 s85, 1, 0
    buffer_load_dwordx4 v[184:187], v156, s[20:23], s73 offen offset:2048 sc1
    v_exp_f32 v57, v57
    v_exp_f32 v58, v58
    v_exp_f32 v59, v59
    v_exp_f32 v60, v60
    v_exp_f32 v61, v61
    v_smfmac_f32_32x32x32_bf16 v[84:99], v[28:31], v[52:59], v1
    ds_read_b128 v[28:31], v6 offset:46464
    v_exp_f32 v62, v62
    v_exp_f32 v63, v63
    v_exp_f32 v64, v64
    v_exp_f32 v65, v65
    v_exp_f32 v66, v66
    v_exp_f32 v67, v67
    v_exp_f32 v36, v36
    v_exp_f32 v37, v37
    v_smfmac_f32_32x32x32_bf16 v[84:99], v[32:35], v[60:67], v1
    s_waitcnt lgkmcnt(0)
    ds_read_b128 v[32:35], v6 offset:47008
    v_exp_f32 v38, v38
    v_exp_f32 v39, v39
    v_exp_f32 v40, v40
    v_mfma_f32_32x32x16_bf16 v[52:67], v[24:27], v[20:23], 0
    ds_read_b128 v[24:27], v3 offset:48576
    v_exp_f32 v41, v41
    v_exp_f32 v42, v42
    v_exp_f32 v43, v43
    v_exp_f32 v44, v44
    v_exp_f32 v45, v45
    v_smfmac_f32_32x32x32_bf16 v[68:83], v[28:31], v[36:43], v1
    s_waitcnt lgkmcnt(1)
    buffer_load_dwordx4 v[188:191], v156, s[20:23], s73 offen offset:3072 sc1
    v_exp_f32 v46, v46
    v_exp_f32 v47, v47
    v_exp_f32 v48, v48
    v_exp_f32 v49, v49
    v_exp_f32 v50, v50
    v_exp_f32 v51, v51
    v_exp_f32 v52, v52
    v_exp_f32 v53, v53
    v_smfmac_f32_32x32x32_bf16 v[68:83], v[32:35], v[44:51], v1
    s_waitcnt lgkmcnt(0)
    buffer_load_dwordx4 v[192:195], v156, s[20:23], s74 offen offset:0 sc1
    v_exp_f32 v54, v54
    v_exp_f32 v55, v55
    v_exp_f32 v56, v56
    v_mfma_f32_32x32x16_bf16 v[36:51], v[24:27], v[16:19], 0
    buffer_load_dwordx4 v[196:199], v156, s[20:23], s74 offen offset:1024 sc1
    v_exp_f32 v57, v57
    v_exp_f32 v58, v58
    v_exp_f32 v59, v59
    v_exp_f32 v60, v60
    v_exp_f32 v61, v61
    v_smfmac_f32_32x32x32_bf16 v[84:99], v[28:31], v[52:59], v1
    ds_read_b128 v[28:31], v6 offset:48576
    v_exp_f32 v62, v62
    v_exp_f32 v63, v63
    v_exp_f32 v64, v64
    v_exp_f32 v65, v65
    v_exp_f32 v66, v66
    v_exp_f32 v67, v67
    v_exp_f32 v36, v36
    v_exp_f32 v37, v37
    v_smfmac_f32_32x32x32_bf16 v[84:99], v[32:35], v[60:67], v1
    s_waitcnt lgkmcnt(0)
    ds_read_b128 v[32:35], v6 offset:49120
    v_exp_f32 v38, v38
    v_exp_f32 v39, v39
    v_exp_f32 v40, v40
    v_mfma_f32_32x32x16_bf16 v[52:67], v[24:27], v[20:23], 0
    ds_read_b128 v[24:27], v3 offset:50688
    v_exp_f32 v41, v41
    v_exp_f32 v42, v42
    v_exp_f32 v43, v43
    v_exp_f32 v44, v44
    v_exp_f32 v45, v45
    v_smfmac_f32_32x32x32_bf16 v[68:83], v[28:31], v[36:43], v1
    s_waitcnt lgkmcnt(1)
    buffer_load_dwordx4 v[200:203], v156, s[20:23], s74 offen offset:2048 sc1
    v_exp_f32 v46, v46
    v_exp_f32 v47, v47
    v_exp_f32 v48, v48
    v_exp_f32 v49, v49
    v_exp_f32 v50, v50
    v_exp_f32 v51, v51
    v_exp_f32 v52, v52
    v_exp_f32 v53, v53
    v_smfmac_f32_32x32x32_bf16 v[68:83], v[32:35], v[44:51], v1
    s_waitcnt lgkmcnt(0)
    buffer_load_dwordx4 v[204:207], v156, s[20:23], s74 offen offset:3072 sc1
    v_exp_f32 v54, v54
    v_exp_f32 v55, v55
    v_exp_f32 v56, v56
    v_mfma_f32_32x32x16_bf16 v[36:51], v[24:27], v[16:19], 0
    buffer_load_dwordx4 v[208:211], v156, s[20:23], s75 offen offset:0 sc1
    v_exp_f32 v57, v57
    v_exp_f32 v58, v58
    v_exp_f32 v59, v59
    v_exp_f32 v60, v60
    v_exp_f32 v61, v61
    v_smfmac_f32_32x32x32_bf16 v[84:99], v[28:31], v[52:59], v1
    ds_read_b128 v[28:31], v6 offset:50688
    v_exp_f32 v62, v62
    v_exp_f32 v63, v63
    v_exp_f32 v64, v64
    v_exp_f32 v65, v65
    v_exp_f32 v66, v66
    v_exp_f32 v67, v67
    v_exp_f32 v36, v36
    v_exp_f32 v37, v37
    v_smfmac_f32_32x32x32_bf16 v[84:99], v[32:35], v[60:67], v1
    s_waitcnt lgkmcnt(0)
    ds_read_b128 v[32:35], v6 offset:51232
    v_exp_f32 v38, v38
    v_exp_f32 v39, v39
    v_exp_f32 v40, v40
    v_mfma_f32_32x32x16_bf16 v[52:67], v[24:27], v[20:23], 0
    ds_read_b128 v[24:27], v3 offset:57024
    v_exp_f32 v41, v41
    v_exp_f32 v42, v42
    v_exp_f32 v43, v43
    v_exp_f32 v44, v44
    v_exp_f32 v45, v45
    v_smfmac_f32_32x32x32_bf16 v[68:83], v[28:31], v[36:43], v1
    s_waitcnt lgkmcnt(1)
    buffer_load_dwordx4 v[212:215], v156, s[20:23], s75 offen offset:1024 sc1
    v_exp_f32 v46, v46
    v_exp_f32 v47, v47
    v_exp_f32 v48, v48
    v_exp_f32 v49, v49
    v_exp_f32 v50, v50
    v_exp_f32 v51, v51
    v_exp_f32 v52, v52
    v_exp_f32 v53, v53
    v_smfmac_f32_32x32x32_bf16 v[68:83], v[32:35], v[44:51], v1
    s_waitcnt lgkmcnt(0)
    buffer_load_dwordx4 v[216:219], v156, s[20:23], s75 offen offset:2048 sc1
    v_exp_f32 v54, v54
    v_exp_f32 v55, v55
    v_exp_f32 v56, v56
    v_mfma_f32_32x32x16_bf16 v[36:51], v[24:27], v[16:19], 0
    buffer_load_dwordx4 v[220:223], v156, s[20:23], s75 offen offset:3072 sc1
    v_exp_f32 v57, v57
    v_exp_f32 v58, v58
    v_exp_f32 v59, v59
    v_exp_f32 v60, v60
    v_exp_f32 v61, v61
    v_smfmac_f32_32x32x32_bf16 v[84:99], v[28:31], v[52:59], v1
    ds_read_b128 v[28:31], v6 offset:57024
    v_exp_f32 v62, v62
    v_exp_f32 v63, v63
    v_exp_f32 v64, v64
    v_exp_f32 v65, v65
    v_exp_f32 v66, v66
    v_exp_f32 v67, v67
    v_exp_f32 v36, v36
    v_exp_f32 v37, v37
    v_smfmac_f32_32x32x32_bf16 v[84:99], v[32:35], v[60:67], v1
    s_waitcnt lgkmcnt(0)
    ds_read_b128 v[32:35], v6 offset:57568
    v_exp_f32 v38, v38
    v_exp_f32 v39, v39
    v_exp_f32 v40, v40
    v_mfma_f32_32x32x16_bf16 v[52:67], v[24:27], v[20:23], 0
    ds_read_b128 v[24:27], v3 offset:59136
    v_exp_f32 v41, v41
    v_exp_f32 v42, v42
    v_exp_f32 v43, v43
    v_exp_f32 v44, v44
    v_exp_f32 v45, v45
    v_smfmac_f32_32x32x32_bf16 v[68:83], v[28:31], v[36:43], v1
    s_waitcnt lgkmcnt(1)
    buffer_load_dwordx4 v[100:103], v158, s[20:23], 0 offen offset:0 sc1
    v_exp_f32 v46, v46
    v_exp_f32 v47, v47
    v_exp_f32 v48, v48
    v_exp_f32 v49, v49
    v_exp_f32 v50, v50
    v_exp_f32 v51, v51
    v_exp_f32 v52, v52
    v_exp_f32 v53, v53
    v_smfmac_f32_32x32x32_bf16 v[68:83], v[32:35], v[44:51], v1
    s_waitcnt lgkmcnt(0)
    buffer_load_dwordx4 v[104:107], v158, s[20:23], 0 offen offset:16 sc1
    v_exp_f32 v54, v54
    v_exp_f32 v55, v55
    v_exp_f32 v56, v56
    v_mfma_f32_32x32x16_bf16 v[36:51], v[24:27], v[16:19], 0
    buffer_load_dwordx4 v[108:111], v158, s[20:23], 0 offen offset:2048 sc1
    v_exp_f32 v57, v57
    v_exp_f32 v58, v58
    v_exp_f32 v59, v59
    v_exp_f32 v60, v60
    v_exp_f32 v61, v61
    v_smfmac_f32_32x32x32_bf16 v[84:99], v[28:31], v[52:59], v1
    ds_read_b128 v[28:31], v6 offset:59136
    v_exp_f32 v62, v62
    v_exp_f32 v63, v63
    v_exp_f32 v64, v64
    v_exp_f32 v65, v65
    v_exp_f32 v66, v66
    v_exp_f32 v67, v67
    v_exp_f32 v36, v36
    v_exp_f32 v37, v37
    v_smfmac_f32_32x32x32_bf16 v[84:99], v[32:35], v[60:67], v1
    s_waitcnt lgkmcnt(0)
    ds_read_b128 v[32:35], v6 offset:59680
    v_exp_f32 v38, v38
    v_exp_f32 v39, v39
    v_exp_f32 v40, v40
    v_mfma_f32_32x32x16_bf16 v[52:67], v[24:27], v[20:23], 0
    ds_read_b128 v[24:27], v3 offset:61248
    v_exp_f32 v41, v41
    v_exp_f32 v42, v42
    v_exp_f32 v43, v43
    v_exp_f32 v44, v44
    v_exp_f32 v45, v45
    v_smfmac_f32_32x32x32_bf16 v[68:83], v[28:31], v[36:43], v1
    s_waitcnt lgkmcnt(1)
    buffer_load_dwordx4 v[112:115], v158, s[20:23], 0 offen offset:2064 sc1
    v_exp_f32 v46, v46
    v_exp_f32 v47, v47
    v_exp_f32 v48, v48
    v_exp_f32 v49, v49
    v_exp_f32 v50, v50
    v_exp_f32 v51, v51
    v_exp_f32 v52, v52
    v_exp_f32 v53, v53
    v_smfmac_f32_32x32x32_bf16 v[68:83], v[32:35], v[44:51], v1
    s_waitcnt lgkmcnt(0)
    buffer_load_dwordx4 a[0:3], v8, s[12:15], s64 offen offset:0 sc1
    v_exp_f32 v54, v54
    v_exp_f32 v55, v55
    v_exp_f32 v56, v56
    v_mfma_f32_32x32x16_bf16 v[36:51], v[24:27], v[16:19], 0
    buffer_load_dwordx4 a[4:7], v9, s[12:15], s64 offen offset:0 sc1
    v_exp_f32 v57, v57
    v_exp_f32 v58, v58
    v_exp_f32 v59, v59
    v_exp_f32 v60, v60
    v_exp_f32 v61, v61
    v_smfmac_f32_32x32x32_bf16 v[84:99], v[28:31], v[52:59], v1
    ds_read_b128 v[28:31], v6 offset:61248
    v_exp_f32 v62, v62
    v_exp_f32 v63, v63
    v_exp_f32 v64, v64
    v_exp_f32 v65, v65
    v_exp_f32 v66, v66
    v_exp_f32 v67, v67
    v_exp_f32 v36, v36
    v_exp_f32 v37, v37
    v_smfmac_f32_32x32x32_bf16 v[84:99], v[32:35], v[60:67], v1
    s_waitcnt lgkmcnt(0)
    ds_read_b128 v[32:35], v6 offset:61792
    v_exp_f32 v38, v38
    v_exp_f32 v39, v39
    v_exp_f32 v40, v40
    v_mfma_f32_32x32x16_bf16 v[52:67], v[24:27], v[20:23], 0
    ds_read_b128 v[24:27], v3 offset:63360
    v_exp_f32 v41, v41
    v_exp_f32 v42, v42
    v_exp_f32 v43, v43
    v_exp_f32 v44, v44
    v_exp_f32 v45, v45
    v_smfmac_f32_32x32x32_bf16 v[68:83], v[28:31], v[36:43], v1
    s_waitcnt lgkmcnt(1)
    buffer_load_dwordx4 a[8:11], v8, s[12:15], s64 offen offset:1024 sc1
    v_exp_f32 v46, v46
    v_exp_f32 v47, v47
    v_exp_f32 v48, v48
    v_exp_f32 v49, v49
    v_exp_f32 v50, v50
    v_exp_f32 v51, v51
    v_exp_f32 v52, v52
    v_exp_f32 v53, v53
    v_smfmac_f32_32x32x32_bf16 v[68:83], v[32:35], v[44:51], v1
    s_waitcnt lgkmcnt(0)
    v_exp_f32 v54, v54
    v_exp_f32 v55, v55
    v_exp_f32 v56, v56
    v_mfma_f32_32x32x16_bf16 v[36:51], v[24:27], v[16:19], 0
    buffer_load_dwordx4 a[12:15], v9, s[12:15], s64 offen offset:1024 sc1
    v_exp_f32 v57, v57
    v_exp_f32 v58, v58
    v_exp_f32 v59, v59
    v_exp_f32 v60, v60
    v_exp_f32 v61, v61
    v_smfmac_f32_32x32x32_bf16 v[84:99], v[28:31], v[52:59], v1
    ds_read_b128 v[28:31], v6 offset:63360
    v_exp_f32 v62, v62
    v_exp_f32 v63, v63
    v_exp_f32 v64, v64
    v_exp_f32 v65, v65
    v_exp_f32 v66, v66
    v_exp_f32 v67, v67
    v_exp_f32 v36, v36
    v_exp_f32 v37, v37
    v_smfmac_f32_32x32x32_bf16 v[84:99], v[32:35], v[60:67], v1
    s_waitcnt lgkmcnt(0)
    ds_read_b128 v[32:35], v6 offset:63904
    v_exp_f32 v38, v38
    v_exp_f32 v39, v39
    v_exp_f32 v40, v40
    v_mfma_f32_32x32x16_bf16 v[52:67], v[24:27], v[20:23], 0
    ds_read_b128 v[24:27], v4 offset:0
    v_exp_f32 v41, v41
    v_exp_f32 v42, v42
    v_exp_f32 v43, v43
    v_exp_f32 v44, v44
    v_exp_f32 v45, v45
    v_smfmac_f32_32x32x32_bf16 v[68:83], v[28:31], v[36:43], v1
    s_waitcnt lgkmcnt(1)
    buffer_load_dwordx4 a[16:19], v8, s[12:15], s64 offen offset:2048 sc1
    v_exp_f32 v46, v46
    v_exp_f32 v47, v47
    v_exp_f32 v48, v48
    v_exp_f32 v49, v49
    v_exp_f32 v50, v50
    v_exp_f32 v51, v51
    v_exp_f32 v52, v52
    v_exp_f32 v53, v53
    v_smfmac_f32_32x32x32_bf16 v[68:83], v[32:35], v[44:51], v1
    s_waitcnt lgkmcnt(0)
    buffer_load_dwordx4 a[20:23], v9, s[12:15], s64 offen offset:2048 sc1
    v_exp_f32 v54, v54
    v_exp_f32 v55, v55
    v_exp_f32 v56, v56
    v_mfma_f32_32x32x16_bf16 v[36:51], v[24:27], v[16:19], 0
    buffer_load_dwordx4 a[24:27], v8, s[12:15], s64 offen offset:3072 sc1
    v_exp_f32 v57, v57
    v_exp_f32 v58, v58
    v_exp_f32 v59, v59
    v_exp_f32 v60, v60
    v_exp_f32 v61, v61
    v_smfmac_f32_32x32x32_bf16 v[84:99], v[28:31], v[52:59], v1
    ds_read_b128 v[28:31], v7 offset:0
    v_exp_f32 v62, v62
    v_exp_f32 v63, v63
    v_exp_f32 v64, v64
    v_exp_f32 v65, v65
    v_exp_f32 v66, v66
    v_exp_f32 v67, v67
    v_exp_f32 v36, v36
    v_exp_f32 v37, v37
    v_smfmac_f32_32x32x32_bf16 v[84:99], v[32:35], v[60:67], v1
    s_waitcnt lgkmcnt(0)
    ds_read_b128 v[32:35], v7 offset:544
    v_exp_f32 v38, v38
    v_exp_f32 v39, v39
    v_exp_f32 v40, v40
    v_mfma_f32_32x32x16_bf16 v[52:67], v[24:27], v[20:23], 0
    ds_read_b128 v[24:27], v4 offset:2112
    v_exp_f32 v41, v41
    v_exp_f32 v42, v42
    v_exp_f32 v43, v43
    v_exp_f32 v44, v44
    v_exp_f32 v45, v45
    v_smfmac_f32_32x32x32_bf16 v[68:83], v[28:31], v[36:43], v1
    s_waitcnt lgkmcnt(1)
    buffer_load_dwordx4 a[28:31], v9, s[12:15], s64 offen offset:3072 sc1
    v_exp_f32 v46, v46
    v_exp_f32 v47, v47
    v_exp_f32 v48, v48
    v_exp_f32 v49, v49
    v_exp_f32 v50, v50
    v_exp_f32 v51, v51
    v_exp_f32 v52, v52
    v_exp_f32 v53, v53
    v_smfmac_f32_32x32x32_bf16 v[68:83], v[32:35], v[44:51], v1
    s_waitcnt lgkmcnt(0)
    buffer_load_dwordx4 a[32:35], v8, s[12:15], s65 offen offset:0 sc1
    v_exp_f32 v54, v54
    v_exp_f32 v55, v55
    v_exp_f32 v56, v56
    v_mfma_f32_32x32x16_bf16 v[36:51], v[24:27], v[16:19], 0
    buffer_load_dwordx4 a[36:39], v9, s[12:15], s65 offen offset:0 sc1
    v_exp_f32 v57, v57
    v_exp_f32 v58, v58
    v_exp_f32 v59, v59
    v_exp_f32 v60, v60
    v_exp_f32 v61, v61
    v_smfmac_f32_32x32x32_bf16 v[84:99], v[28:31], v[52:59], v1
    ds_read_b128 v[28:31], v7 offset:2112
    v_exp_f32 v62, v62
    v_exp_f32 v63, v63
    v_exp_f32 v64, v64
    v_exp_f32 v65, v65
    v_exp_f32 v66, v66
    v_exp_f32 v67, v67
    v_exp_f32 v36, v36
    v_exp_f32 v37, v37
    v_smfmac_f32_32x32x32_bf16 v[84:99], v[32:35], v[60:67], v1
    s_waitcnt lgkmcnt(0)
    ds_read_b128 v[32:35], v7 offset:2656
    v_exp_f32 v38, v38
    v_exp_f32 v39, v39
    v_exp_f32 v40, v40
    v_mfma_f32_32x32x16_bf16 v[52:67], v[24:27], v[20:23], 0
    s_waitcnt vmcnt(31)
    s_waitcnt lgkmcnt(0)
    s_barrier
    ds_read_b128 v[24:27], v2 offset:0
    v_exp_f32 v41, v41
    v_exp_f32 v42, v42
    v_exp_f32 v43, v43
    v_exp_f32 v44, v44
    v_exp_f32 v45, v45
    v_smfmac_f32_32x32x32_bf16 v[68:83], v[28:31], v[36:43], v1
    s_waitcnt lgkmcnt(1)
    buffer_load_dwordx4 a[40:43], v8, s[12:15], s65 offen offset:1024 sc1
    v_exp_f32 v46, v46
    v_exp_f32 v47, v47
    v_exp_f32 v48, v48
    v_exp_f32 v49, v49
    v_exp_f32 v50, v50
    v_exp_f32 v51, v51
    v_exp_f32 v52, v52
    v_exp_f32 v53, v53
    v_smfmac_f32_32x32x32_bf16 v[68:83], v[32:35], v[44:51], v1
    s_waitcnt lgkmcnt(0)
    buffer_load_dwordx4 a[44:47], v9, s[12:15], s65 offen offset:1024 sc1
    v_exp_f32 v54, v54
    v_exp_f32 v55, v55
    v_exp_f32 v56, v56
    v_mfma_f32_32x32x16_bf16 v[36:51], v[24:27], v[16:19], 0
    buffer_load_dwordx4 a[48:51], v8, s[12:15], s65 offen offset:2048 sc1
    v_exp_f32 v57, v57
    v_exp_f32 v58, v58
    v_exp_f32 v59, v59
    v_exp_f32 v60, v60
    v_exp_f32 v61, v61
    v_smfmac_f32_32x32x32_bf16 v[84:99], v[28:31], v[52:59], v1
    ds_read_b128 v[28:31], v5 offset:0
    v_exp_f32 v62, v62
    v_exp_f32 v63, v63
    v_exp_f32 v64, v64
    v_exp_f32 v65, v65
    v_exp_f32 v66, v66
    v_exp_f32 v67, v67
    v_exp_f32 v36, v36
    v_exp_f32 v37, v37
    v_smfmac_f32_32x32x32_bf16 v[84:99], v[32:35], v[60:67], v1
    s_waitcnt lgkmcnt(0)
    ds_read_b128 v[32:35], v5 offset:544
    v_exp_f32 v38, v38
    v_exp_f32 v39, v39
    v_exp_f32 v40, v40
    v_mfma_f32_32x32x16_bf16 v[52:67], v[24:27], v[20:23], 0
    ds_read_b128 v[24:27], v2 offset:2112
    v_exp_f32 v41, v41
    v_exp_f32 v42, v42
    v_exp_f32 v43, v43
    v_exp_f32 v44, v44
    v_exp_f32 v45, v45
    v_smfmac_f32_32x32x32_bf16 v[68:83], v[28:31], v[36:43], v1
    s_waitcnt lgkmcnt(1)
    buffer_load_dwordx4 a[52:55], v9, s[12:15], s65 offen offset:2048 sc1
    v_exp_f32 v46, v46
    v_exp_f32 v47, v47
    v_exp_f32 v48, v48
    v_exp_f32 v49, v49
    v_exp_f32 v50, v50
    v_exp_f32 v51, v51
    v_exp_f32 v52, v52
    v_exp_f32 v53, v53
    v_smfmac_f32_32x32x32_bf16 v[68:83], v[32:35], v[44:51], v1
    s_waitcnt lgkmcnt(0)
    buffer_load_dwordx4 a[56:59], v8, s[12:15], s65 offen offset:3072 sc1
    v_exp_f32 v54, v54
    v_exp_f32 v55, v55
    v_exp_f32 v56, v56
    v_mfma_f32_32x32x16_bf16 v[36:51], v[24:27], v[16:19], 0
    buffer_load_dwordx4 a[60:63], v9, s[12:15], s65 offen offset:3072 sc1
    v_exp_f32 v57, v57
    v_exp_f32 v58, v58
    v_exp_f32 v59, v59
    v_exp_f32 v60, v60
    v_exp_f32 v61, v61
    v_smfmac_f32_32x32x32_bf16 v[84:99], v[28:31], v[52:59], v1
    ds_read_b128 v[28:31], v5 offset:2112
    v_exp_f32 v62, v62
    v_exp_f32 v63, v63
    v_exp_f32 v64, v64
    v_exp_f32 v65, v65
    v_exp_f32 v66, v66
    v_exp_f32 v67, v67
    v_exp_f32 v36, v36
    v_exp_f32 v37, v37
    v_smfmac_f32_32x32x32_bf16 v[84:99], v[32:35], v[60:67], v1
    s_waitcnt lgkmcnt(0)
    ds_read_b128 v[32:35], v5 offset:2656
    v_exp_f32 v38, v38
    v_exp_f32 v39, v39
    v_exp_f32 v40, v40
    v_mfma_f32_32x32x16_bf16 v[52:67], v[24:27], v[20:23], 0
    ds_read_b128 v[24:27], v2 offset:4224
    v_exp_f32 v41, v41
    v_exp_f32 v42, v42
    v_exp_f32 v43, v43
    v_exp_f32 v44, v44
    v_exp_f32 v45, v45
    v_smfmac_f32_32x32x32_bf16 v[68:83], v[28:31], v[36:43], v1
    s_waitcnt lgkmcnt(1)
    buffer_load_dwordx4 a[64:67], v8, s[12:15], s66 offen offset:0 sc1
    v_exp_f32 v46, v46
    v_exp_f32 v47, v47
    v_exp_f32 v48, v48
    v_exp_f32 v49, v49
    v_exp_f32 v50, v50
    v_exp_f32 v51, v51
    v_exp_f32 v52, v52
    v_exp_f32 v53, v53
    v_smfmac_f32_32x32x32_bf16 v[68:83], v[32:35], v[44:51], v1
    s_waitcnt lgkmcnt(0)
    buffer_load_dwordx4 a[68:71], v9, s[12:15], s66 offen offset:0 sc1
    v_exp_f32 v54, v54
    v_exp_f32 v55, v55
    v_exp_f32 v56, v56
    v_mfma_f32_32x32x16_bf16 v[36:51], v[24:27], v[16:19], 0
    buffer_load_dwordx4 a[72:75], v8, s[12:15], s66 offen offset:1024 sc1
    v_exp_f32 v57, v57
    v_exp_f32 v58, v58
    v_exp_f32 v59, v59
    v_exp_f32 v60, v60
    v_exp_f32 v61, v61
    v_smfmac_f32_32x32x32_bf16 v[84:99], v[28:31], v[52:59], v1
    ds_read_b128 v[28:31], v5 offset:4224
    v_exp_f32 v62, v62
    v_exp_f32 v63, v63
    v_exp_f32 v64, v64
    v_exp_f32 v65, v65
    v_exp_f32 v66, v66
    v_exp_f32 v67, v67
    v_exp_f32 v36, v36
    v_exp_f32 v37, v37
    v_smfmac_f32_32x32x32_bf16 v[84:99], v[32:35], v[60:67], v1
    s_waitcnt lgkmcnt(0)
    ds_read_b128 v[32:35], v5 offset:4768
    v_exp_f32 v38, v38
    v_exp_f32 v39, v39
    v_exp_f32 v40, v40
    v_mfma_f32_32x32x16_bf16 v[52:67], v[24:27], v[20:23], 0
    ds_read_b128 v[24:27], v2 offset:6336
    v_exp_f32 v41, v41
    v_exp_f32 v42, v42
    v_exp_f32 v43, v43
    v_exp_f32 v44, v44
    v_exp_f32 v45, v45
    v_smfmac_f32_32x32x32_bf16 v[68:83], v[28:31], v[36:43], v1
    s_waitcnt lgkmcnt(1)
    buffer_load_dwordx4 a[76:79], v9, s[12:15], s66 offen offset:1024 sc1
    v_exp_f32 v46, v46
    v_exp_f32 v47, v47
    v_exp_f32 v48, v48
    v_exp_f32 v49, v49
    v_exp_f32 v50, v50
    v_exp_f32 v51, v51
    v_exp_f32 v52, v52
    v_exp_f32 v53, v53
    v_smfmac_f32_32x32x32_bf16 v[68:83], v[32:35], v[44:51], v1
    s_waitcnt lgkmcnt(0)
    buffer_load_dwordx4 a[80:83], v8, s[12:15], s66 offen offset:2048 sc1
    v_exp_f32 v54, v54
    v_exp_f32 v55, v55
    v_exp_f32 v56, v56
    v_mfma_f32_32x32x16_bf16 v[36:51], v[24:27], v[16:19], 0
    buffer_load_dwordx4 a[84:87], v9, s[12:15], s66 offen offset:2048 sc1
    v_exp_f32 v57, v57
    v_exp_f32 v58, v58
    v_exp_f32 v59, v59
    v_exp_f32 v60, v60
    v_exp_f32 v61, v61
    v_smfmac_f32_32x32x32_bf16 v[84:99], v[28:31], v[52:59], v1
    ds_read_b128 v[28:31], v5 offset:6336
    v_exp_f32 v62, v62
    v_exp_f32 v63, v63
    v_exp_f32 v64, v64
    v_exp_f32 v65, v65
    v_exp_f32 v66, v66
    v_exp_f32 v67, v67
    v_exp_f32 v36, v36
    v_exp_f32 v37, v37
    v_smfmac_f32_32x32x32_bf16 v[84:99], v[32:35], v[60:67], v1
    s_waitcnt lgkmcnt(0)
    ds_read_b128 v[32:35], v5 offset:6880
    v_exp_f32 v38, v38
    v_exp_f32 v39, v39
    v_exp_f32 v40, v40
    v_mfma_f32_32x32x16_bf16 v[52:67], v[24:27], v[20:23], 0
    ds_read_b128 v[24:27], v2 offset:8448
    v_exp_f32 v41, v41
    v_exp_f32 v42, v42
    v_exp_f32 v43, v43
    v_exp_f32 v44, v44
    v_exp_f32 v45, v45
    v_smfmac_f32_32x32x32_bf16 v[68:83], v[28:31], v[36:43], v1
    s_waitcnt lgkmcnt(1)
    buffer_load_dwordx4 a[88:91], v8, s[12:15], s66 offen offset:3072 sc1
    v_exp_f32 v46, v46
    v_exp_f32 v47, v47
    v_exp_f32 v48, v48
    v_exp_f32 v49, v49
    v_exp_f32 v50, v50
    v_exp_f32 v51, v51
    v_exp_f32 v52, v52
    v_exp_f32 v53, v53
    v_smfmac_f32_32x32x32_bf16 v[68:83], v[32:35], v[44:51], v1
    s_waitcnt lgkmcnt(0)
    buffer_load_dwordx4 a[92:95], v9, s[12:15], s66 offen offset:3072 sc1
    v_exp_f32 v54, v54
    v_exp_f32 v55, v55
    v_exp_f32 v56, v56
    v_mfma_f32_32x32x16_bf16 v[36:51], v[24:27], v[16:19], 0
    buffer_load_dwordx4 a[96:99], v8, s[12:15], s67 offen offset:0 sc1
    v_exp_f32 v57, v57
    v_exp_f32 v58, v58
    v_exp_f32 v59, v59
    v_exp_f32 v60, v60
    v_exp_f32 v61, v61
    v_smfmac_f32_32x32x32_bf16 v[84:99], v[28:31], v[52:59], v1
    ds_read_b128 v[28:31], v5 offset:8448
    v_exp_f32 v62, v62
    v_exp_f32 v63, v63
    v_exp_f32 v64, v64
    v_exp_f32 v65, v65
    v_exp_f32 v66, v66
    v_exp_f32 v67, v67
    v_exp_f32 v36, v36
    v_exp_f32 v37, v37
    v_smfmac_f32_32x32x32_bf16 v[84:99], v[32:35], v[60:67], v1
    s_waitcnt lgkmcnt(0)
    ds_read_b128 v[32:35], v5 offset:8992
    v_exp_f32 v38, v38
    v_exp_f32 v39, v39
    v_exp_f32 v40, v40
    v_mfma_f32_32x32x16_bf16 v[52:67], v[24:27], v[20:23], 0
    ds_read_b128 v[24:27], v2 offset:10560
    v_exp_f32 v41, v41
    v_exp_f32 v42, v42
    v_exp_f32 v43, v43
    v_exp_f32 v44, v44
    v_exp_f32 v45, v45
    v_smfmac_f32_32x32x32_bf16 v[68:83], v[28:31], v[36:43], v1
    s_waitcnt lgkmcnt(1)
    buffer_load_dwordx4 a[100:103], v9, s[12:15], s67 offen offset:0 sc1
    v_exp_f32 v46, v46
    v_exp_f32 v47, v47
    v_exp_f32 v48, v48
    v_exp_f32 v49, v49
    v_exp_f32 v50, v50
    v_exp_f32 v51, v51
    v_exp_f32 v52, v52
    v_exp_f32 v53, v53
    v_smfmac_f32_32x32x32_bf16 v[68:83], v[32:35], v[44:51], v1
    s_waitcnt lgkmcnt(0)
    v_exp_f32 v54, v54
    v_exp_f32 v55, v55
    v_exp_f32 v56, v56
    v_mfma_f32_32x32x16_bf16 v[36:51], v[24:27], v[16:19], 0
    buffer_load_dwordx4 a[104:107], v8, s[12:15], s67 offen offset:1024 sc1
    v_exp_f32 v57, v57
    v_exp_f32 v58, v58
    v_exp_f32 v59, v59
    v_exp_f32 v60, v60
    v_exp_f32 v61, v61
    v_smfmac_f32_32x32x32_bf16 v[84:99], v[28:31], v[52:59], v1
    ds_read_b128 v[28:31], v5 offset:10560
    v_exp_f32 v62, v62
    v_exp_f32 v63, v63
    v_exp_f32 v64, v64
    v_exp_f32 v65, v65
    v_exp_f32 v66, v66
    v_exp_f32 v67, v67
    v_exp_f32 v36, v36
    v_exp_f32 v37, v37
    v_smfmac_f32_32x32x32_bf16 v[84:99], v[32:35], v[60:67], v1
    s_waitcnt lgkmcnt(0)
    ds_read_b128 v[32:35], v5 offset:11104
    v_exp_f32 v38, v38
    v_exp_f32 v39, v39
    v_exp_f32 v40, v40
    v_mfma_f32_32x32x16_bf16 v[52:67], v[24:27], v[20:23], 0
    ds_read_b128 v[24:27], v2 offset:12672
    v_exp_f32 v41, v41
    v_exp_f32 v42, v42
    v_exp_f32 v43, v43
    v_exp_f32 v44, v44
    v_exp_f32 v45, v45
    v_smfmac_f32_32x32x32_bf16 v[68:83], v[28:31], v[36:43], v1
    s_waitcnt lgkmcnt(1)
    buffer_load_dwordx4 a[108:111], v9, s[12:15], s67 offen offset:1024 sc1
    v_exp_f32 v46, v46
    v_exp_f32 v47, v47
    v_exp_f32 v48, v48
    v_exp_f32 v49, v49
    v_exp_f32 v50, v50
    v_exp_f32 v51, v51
    v_exp_f32 v52, v52
    v_exp_f32 v53, v53
    v_smfmac_f32_32x32x32_bf16 v[68:83], v[32:35], v[44:51], v1
    s_waitcnt lgkmcnt(0)
    buffer_load_dwordx4 a[112:115], v8, s[12:15], s67 offen offset:2048 sc1
    v_exp_f32 v54, v54
    v_exp_f32 v55, v55
    v_exp_f32 v56, v56
    v_mfma_f32_32x32x16_bf16 v[36:51], v[24:27], v[16:19], 0
    buffer_load_dwordx4 a[116:119], v9, s[12:15], s67 offen offset:2048 sc1
    v_exp_f32 v57, v57
    v_exp_f32 v58, v58
    v_exp_f32 v59, v59
    v_exp_f32 v60, v60
    v_exp_f32 v61, v61
    v_smfmac_f32_32x32x32_bf16 v[84:99], v[28:31], v[52:59], v1
    ds_read_b128 v[28:31], v5 offset:12672
    v_exp_f32 v62, v62
    v_exp_f32 v63, v63
    v_exp_f32 v64, v64
    v_exp_f32 v65, v65
    v_exp_f32 v66, v66
    v_exp_f32 v67, v67
    v_exp_f32 v36, v36
    v_exp_f32 v37, v37
    v_smfmac_f32_32x32x32_bf16 v[84:99], v[32:35], v[60:67], v1
    s_waitcnt lgkmcnt(0)
    ds_read_b128 v[32:35], v5 offset:13216
    v_exp_f32 v38, v38
    v_exp_f32 v39, v39
    v_exp_f32 v40, v40
    v_mfma_f32_32x32x16_bf16 v[52:67], v[24:27], v[20:23], 0
    ds_read_b128 v[24:27], v2 offset:14784
    v_exp_f32 v41, v41
    v_exp_f32 v42, v42
    v_exp_f32 v43, v43
    v_exp_f32 v44, v44
    v_exp_f32 v45, v45
    v_smfmac_f32_32x32x32_bf16 v[68:83], v[28:31], v[36:43], v1
    s_waitcnt lgkmcnt(1)
    buffer_load_dwordx4 a[120:123], v8, s[12:15], s67 offen offset:3072 sc1
    v_exp_f32 v46, v46
    v_exp_f32 v47, v47
    v_exp_f32 v48, v48
    v_exp_f32 v49, v49
    v_exp_f32 v50, v50
    v_exp_f32 v51, v51
    v_exp_f32 v52, v52
    v_exp_f32 v53, v53
    v_smfmac_f32_32x32x32_bf16 v[68:83], v[32:35], v[44:51], v1
    s_waitcnt lgkmcnt(0)
    buffer_load_dwordx4 a[124:127], v9, s[12:15], s67 offen offset:3072 sc1
    v_exp_f32 v54, v54
    v_exp_f32 v55, v55
    v_exp_f32 v56, v56
    v_mfma_f32_32x32x16_bf16 v[36:51], v[24:27], v[16:19], 0
    buffer_load_dwordx4 a[128:131], v8, s[12:15], s68 offen offset:0 sc1
    v_exp_f32 v57, v57
    v_exp_f32 v58, v58
    v_exp_f32 v59, v59
    v_exp_f32 v60, v60
    v_exp_f32 v61, v61
    v_smfmac_f32_32x32x32_bf16 v[84:99], v[28:31], v[52:59], v1
    ds_read_b128 v[28:31], v5 offset:14784
    v_exp_f32 v62, v62
    v_exp_f32 v63, v63
    v_exp_f32 v64, v64
    v_exp_f32 v65, v65
    v_exp_f32 v66, v66
    v_exp_f32 v67, v67
    v_exp_f32 v36, v36
    v_exp_f32 v37, v37
    v_smfmac_f32_32x32x32_bf16 v[84:99], v[32:35], v[60:67], v1
    s_waitcnt lgkmcnt(0)
    ds_read_b128 v[32:35], v5 offset:15328
    v_exp_f32 v38, v38
    v_exp_f32 v39, v39
    v_exp_f32 v40, v40
    v_mfma_f32_32x32x16_bf16 v[52:67], v[24:27], v[20:23], 0
    ds_read_b128 v[24:27], v2 offset:16896
    v_exp_f32 v41, v41
    v_exp_f32 v42, v42
    v_exp_f32 v43, v43
    v_exp_f32 v44, v44
    v_exp_f32 v45, v45
    v_smfmac_f32_32x32x32_bf16 v[68:83], v[28:31], v[36:43], v1
    s_waitcnt lgkmcnt(1)
    buffer_load_dwordx4 a[132:135], v9, s[12:15], s68 offen offset:0 sc1
    v_exp_f32 v46, v46
    v_exp_f32 v47, v47
    v_exp_f32 v48, v48
    v_exp_f32 v49, v49
    v_exp_f32 v50, v50
    v_exp_f32 v51, v51
    v_exp_f32 v52, v52
    v_exp_f32 v53, v53
    v_smfmac_f32_32x32x32_bf16 v[68:83], v[32:35], v[44:51], v1
    s_waitcnt lgkmcnt(0)
    buffer_load_dwordx4 a[136:139], v8, s[12:15], s68 offen offset:1024 sc1
    v_exp_f32 v54, v54
    v_exp_f32 v55, v55
    v_exp_f32 v56, v56
    v_mfma_f32_32x32x16_bf16 v[36:51], v[24:27], v[16:19], 0
    buffer_load_dwordx4 a[140:143], v9, s[12:15], s68 offen offset:1024 sc1
    v_exp_f32 v57, v57
    v_exp_f32 v58, v58
    v_exp_f32 v59, v59
    v_exp_f32 v60, v60
    v_exp_f32 v61, v61
    v_smfmac_f32_32x32x32_bf16 v[84:99], v[28:31], v[52:59], v1
    ds_read_b128 v[28:31], v5 offset:16896
    v_exp_f32 v62, v62
    v_exp_f32 v63, v63
    v_exp_f32 v64, v64
    v_exp_f32 v65, v65
    v_exp_f32 v66, v66
    v_exp_f32 v67, v67
    v_exp_f32 v36, v36
    v_exp_f32 v37, v37
    v_smfmac_f32_32x32x32_bf16 v[84:99], v[32:35], v[60:67], v1
    s_waitcnt lgkmcnt(0)
    ds_read_b128 v[32:35], v5 offset:17440
    v_exp_f32 v38, v38
    v_exp_f32 v39, v39
    v_exp_f32 v40, v40
    v_mfma_f32_32x32x16_bf16 v[52:67], v[24:27], v[20:23], 0
    ds_read_b128 v[24:27], v2 offset:19008
    v_exp_f32 v41, v41
    v_exp_f32 v42, v42
    v_exp_f32 v43, v43
    v_exp_f32 v44, v44
    v_exp_f32 v45, v45
    v_smfmac_f32_32x32x32_bf16 v[68:83], v[28:31], v[36:43], v1
    s_waitcnt lgkmcnt(1)
    buffer_load_dwordx4 a[144:147], v8, s[12:15], s68 offen offset:2048 sc1
    v_exp_f32 v46, v46
    v_exp_f32 v47, v47
    v_exp_f32 v48, v48
    v_exp_f32 v49, v49
    v_exp_f32 v50, v50
    v_exp_f32 v51, v51
    v_exp_f32 v52, v52
    v_exp_f32 v53, v53
    v_smfmac_f32_32x32x32_bf16 v[68:83], v[32:35], v[44:51], v1
    s_waitcnt lgkmcnt(0)
    s_mov_b32 exec_lo, 0
    s_mov_b32 exec_hi, 4095
    buffer_load_dword v14, v128, s[20:23], 0 offen sc1
    s_mov_b64 exec, -1
    v_exp_f32 v54, v54
    v_exp_f32 v55, v55
    v_exp_f32 v56, v56
    v_mfma_f32_32x32x16_bf16 v[36:51], v[24:27], v[16:19], 0
    buffer_load_dwordx4 a[148:151], v9, s[12:15], s68 offen offset:2048 sc1
    v_exp_f32 v57, v57
    v_exp_f32 v58, v58
    v_exp_f32 v59, v59
    v_exp_f32 v60, v60
    v_exp_f32 v61, v61
    v_smfmac_f32_32x32x32_bf16 v[84:99], v[28:31], v[52:59], v1
    ds_read_b128 v[28:31], v5 offset:19008
    v_exp_f32 v62, v62
    v_exp_f32 v63, v63
    v_exp_f32 v64, v64
    v_exp_f32 v65, v65
    v_exp_f32 v66, v66
    v_exp_f32 v67, v67
    v_exp_f32 v36, v36
    v_exp_f32 v37, v37
    v_smfmac_f32_32x32x32_bf16 v[84:99], v[32:35], v[60:67], v1
    s_waitcnt lgkmcnt(0)
    ds_read_b128 v[32:35], v5 offset:19552
    v_exp_f32 v38, v38
    v_exp_f32 v39, v39
    v_exp_f32 v40, v40
    v_mfma_f32_32x32x16_bf16 v[52:67], v[24:27], v[20:23], 0
    ds_read_b128 v[24:27], v2 offset:21120
    v_exp_f32 v41, v41
    v_exp_f32 v42, v42
    v_exp_f32 v43, v43
    v_exp_f32 v44, v44
    v_exp_f32 v45, v45
    v_smfmac_f32_32x32x32_bf16 v[68:83], v[28:31], v[36:43], v1
    s_waitcnt lgkmcnt(1)
    buffer_load_dwordx4 a[152:155], v8, s[12:15], s68 offen offset:3072 sc1
    v_exp_f32 v46, v46
    v_exp_f32 v47, v47
    v_exp_f32 v48, v48
    v_exp_f32 v49, v49
    v_exp_f32 v50, v50
    v_exp_f32 v51, v51
    v_exp_f32 v52, v52
    v_exp_f32 v53, v53
    v_smfmac_f32_32x32x32_bf16 v[68:83], v[32:35], v[44:51], v1
    s_waitcnt lgkmcnt(0)
    buffer_load_dwordx4 a[156:159], v9, s[12:15], s68 offen offset:3072 sc1
    v_exp_f32 v54, v54
    v_exp_f32 v55, v55
    v_exp_f32 v56, v56
    v_mfma_f32_32x32x16_bf16 v[36:51], v[24:27], v[16:19], 0
    buffer_load_dwordx4 a[160:163], v8, s[12:15], s69 offen offset:0 sc1
    v_exp_f32 v57, v57
    v_exp_f32 v58, v58
    v_exp_f32 v59, v59
    v_exp_f32 v60, v60
    v_exp_f32 v61, v61
    v_smfmac_f32_32x32x32_bf16 v[84:99], v[28:31], v[52:59], v1
    ds_read_b128 v[28:31], v5 offset:21120
    v_exp_f32 v62, v62
    v_exp_f32 v63, v63
    v_exp_f32 v64, v64
    v_exp_f32 v65, v65
    v_exp_f32 v66, v66
    v_exp_f32 v67, v67
    v_exp_f32 v36, v36
    v_exp_f32 v37, v37
    v_smfmac_f32_32x32x32_bf16 v[84:99], v[32:35], v[60:67], v1
    s_waitcnt lgkmcnt(0)
    ds_read_b128 v[32:35], v5 offset:21664
    v_exp_f32 v38, v38
    v_exp_f32 v39, v39
    v_exp_f32 v40, v40
    v_mfma_f32_32x32x16_bf16 v[52:67], v[24:27], v[20:23], 0
    ds_read_b128 v[24:27], v2 offset:23232
    v_exp_f32 v41, v41
    v_exp_f32 v42, v42
    v_exp_f32 v43, v43
    v_exp_f32 v44, v44
    v_exp_f32 v45, v45
    v_smfmac_f32_32x32x32_bf16 v[68:83], v[28:31], v[36:43], v1
    s_waitcnt lgkmcnt(1)
    buffer_load_dwordx4 a[164:167], v9, s[12:15], s69 offen offset:0 sc1
    v_exp_f32 v46, v46
    v_exp_f32 v47, v47
    v_exp_f32 v48, v48
    v_exp_f32 v49, v49
    v_exp_f32 v50, v50
    v_exp_f32 v51, v51
    v_exp_f32 v52, v52
    v_exp_f32 v53, v53
    v_smfmac_f32_32x32x32_bf16 v[68:83], v[32:35], v[44:51], v1
    s_waitcnt lgkmcnt(0)
    buffer_load_dwordx4 a[168:171], v8, s[12:15], s69 offen offset:1024 sc1
    v_exp_f32 v54, v54
    v_exp_f32 v55, v55
    v_exp_f32 v56, v56
    v_mfma_f32_32x32x16_bf16 v[36:51], v[24:27], v[16:19], 0
    buffer_load_dwordx4 a[172:175], v9, s[12:15], s69 offen offset:1024 sc1
    v_exp_f32 v57, v57
    v_exp_f32 v58, v58
    v_exp_f32 v59, v59
    v_exp_f32 v60, v60
    v_exp_f32 v61, v61
    v_smfmac_f32_32x32x32_bf16 v[84:99], v[28:31], v[52:59], v1
    ds_read_b128 v[28:31], v5 offset:23232
    v_exp_f32 v62, v62
    v_exp_f32 v63, v63
    v_exp_f32 v64, v64
    v_exp_f32 v65, v65
    v_exp_f32 v66, v66
    v_exp_f32 v67, v67
    v_exp_f32 v36, v36
    v_exp_f32 v37, v37
    v_smfmac_f32_32x32x32_bf16 v[84:99], v[32:35], v[60:67], v1
    s_waitcnt lgkmcnt(0)
    ds_read_b128 v[32:35], v5 offset:23776
    v_exp_f32 v38, v38
    v_exp_f32 v39, v39
    v_exp_f32 v40, v40
    v_mfma_f32_32x32x16_bf16 v[52:67], v[24:27], v[20:23], 0
    ds_read_b128 v[24:27], v2 offset:25344
    v_exp_f32 v41, v41
    v_exp_f32 v42, v42
    v_exp_f32 v43, v43
    v_exp_f32 v44, v44
    v_exp_f32 v45, v45
    v_smfmac_f32_32x32x32_bf16 v[68:83], v[28:31], v[36:43], v1
    s_waitcnt lgkmcnt(1)
    buffer_load_dwordx4 a[176:179], v8, s[12:15], s69 offen offset:2048 sc1
    v_exp_f32 v46, v46
    v_exp_f32 v47, v47
    v_exp_f32 v48, v48
    v_exp_f32 v49, v49
    v_exp_f32 v50, v50
    v_exp_f32 v51, v51
    v_exp_f32 v52, v52
    v_exp_f32 v53, v53
    v_smfmac_f32_32x32x32_bf16 v[68:83], v[32:35], v[44:51], v1
    s_waitcnt lgkmcnt(0)
    buffer_load_dwordx4 a[180:183], v9, s[12:15], s69 offen offset:2048 sc1
    v_exp_f32 v54, v54
    v_exp_f32 v55, v55
    v_exp_f32 v56, v56
    v_mfma_f32_32x32x16_bf16 v[36:51], v[24:27], v[16:19], 0
    buffer_load_dwordx4 a[184:187], v8, s[12:15], s69 offen offset:3072 sc1
    v_exp_f32 v57, v57
    v_exp_f32 v58, v58
    v_exp_f32 v59, v59
    v_exp_f32 v60, v60
    v_exp_f32 v61, v61
    v_smfmac_f32_32x32x32_bf16 v[84:99], v[28:31], v[52:59], v1
    ds_read_b128 v[28:31], v5 offset:25344
    v_exp_f32 v62, v62
    v_exp_f32 v63, v63
    v_exp_f32 v64, v64
    v_exp_f32 v65, v65
    v_exp_f32 v66, v66
    v_exp_f32 v67, v67
    v_exp_f32 v36, v36
    v_exp_f32 v37, v37
    v_smfmac_f32_32x32x32_bf16 v[84:99], v[32:35], v[60:67], v1
    s_waitcnt lgkmcnt(0)
    ds_read_b128 v[32:35], v5 offset:25888
    v_exp_f32 v38, v38
    v_exp_f32 v39, v39
    v_exp_f32 v40, v40
    v_mfma_f32_32x32x16_bf16 v[52:67], v[24:27], v[20:23], 0
    ds_read_b128 v[24:27], v2 offset:27456
    v_exp_f32 v41, v41
    v_exp_f32 v42, v42
    v_exp_f32 v43, v43
    v_exp_f32 v44, v44
    v_exp_f32 v45, v45
    v_smfmac_f32_32x32x32_bf16 v[68:83], v[28:31], v[36:43], v1
    s_waitcnt lgkmcnt(1)
    buffer_load_dwordx4 a[188:191], v9, s[12:15], s69 offen offset:3072 sc1
    v_exp_f32 v46, v46
    v_exp_f32 v47, v47
    v_exp_f32 v48, v48
    v_exp_f32 v49, v49
    v_exp_f32 v50, v50
    v_exp_f32 v51, v51
    v_exp_f32 v52, v52
    v_exp_f32 v53, v53
    v_smfmac_f32_32x32x32_bf16 v[68:83], v[32:35], v[44:51], v1
    s_waitcnt lgkmcnt(0)
    buffer_load_dwordx4 a[192:195], v8, s[12:15], s70 offen offset:0 sc1
    v_exp_f32 v54, v54
    v_exp_f32 v55, v55
    v_exp_f32 v56, v56
    v_mfma_f32_32x32x16_bf16 v[36:51], v[24:27], v[16:19], 0
    v_exp_f32 v57, v57
    v_exp_f32 v58, v58
    v_exp_f32 v59, v59
    v_exp_f32 v60, v60
    v_exp_f32 v61, v61
    v_smfmac_f32_32x32x32_bf16 v[84:99], v[28:31], v[52:59], v1
    ds_read_b128 v[28:31], v5 offset:27456
    v_exp_f32 v62, v62
    v_exp_f32 v63, v63
    v_exp_f32 v64, v64
    v_exp_f32 v65, v65
    v_exp_f32 v66, v66
    v_exp_f32 v67, v67
    v_exp_f32 v36, v36
    v_exp_f32 v37, v37
    v_smfmac_f32_32x32x32_bf16 v[84:99], v[32:35], v[60:67], v1
    s_waitcnt lgkmcnt(0)
    ds_read_b128 v[32:35], v5 offset:28000
    v_exp_f32 v38, v38
    v_exp_f32 v39, v39
    v_exp_f32 v40, v40
    v_mfma_f32_32x32x16_bf16 v[52:67], v[24:27], v[20:23], 0
    ds_read_b128 v[24:27], v2 offset:29568
    v_exp_f32 v41, v41
    v_exp_f32 v42, v42
    v_exp_f32 v43, v43
    v_exp_f32 v44, v44
    v_exp_f32 v45, v45
    v_smfmac_f32_32x32x32_bf16 v[68:83], v[28:31], v[36:43], v1
    s_waitcnt lgkmcnt(1)
    buffer_load_dwordx4 a[196:199], v9, s[12:15], s70 offen offset:0 sc1
    v_exp_f32 v46, v46
    v_exp_f32 v47, v47
    v_exp_f32 v48, v48
    v_exp_f32 v49, v49
    v_exp_f32 v50, v50
    v_exp_f32 v51, v51
    v_exp_f32 v52, v52
    v_exp_f32 v53, v53
    v_smfmac_f32_32x32x32_bf16 v[68:83], v[32:35], v[44:51], v1
    s_waitcnt lgkmcnt(0)
    buffer_load_dwordx4 a[200:203], v8, s[12:15], s70 offen offset:1024 sc1
    v_exp_f32 v54, v54
    v_exp_f32 v55, v55
    v_exp_f32 v56, v56
    v_mfma_f32_32x32x16_bf16 v[36:51], v[24:27], v[16:19], 0
    buffer_load_dwordx4 a[204:207], v9, s[12:15], s70 offen offset:1024 sc1
    v_exp_f32 v57, v57
    v_exp_f32 v58, v58
    v_exp_f32 v59, v59
    v_exp_f32 v60, v60
    v_exp_f32 v61, v61
    v_smfmac_f32_32x32x32_bf16 v[84:99], v[28:31], v[52:59], v1
    ds_read_b128 v[28:31], v5 offset:29568
    v_exp_f32 v62, v62
    v_exp_f32 v63, v63
    v_exp_f32 v64, v64
    v_exp_f32 v65, v65
    v_exp_f32 v66, v66
    v_exp_f32 v67, v67
    v_exp_f32 v36, v36
    v_exp_f32 v37, v37
    v_smfmac_f32_32x32x32_bf16 v[84:99], v[32:35], v[60:67], v1
    s_waitcnt lgkmcnt(0)
    ds_read_b128 v[32:35], v5 offset:30112
    v_exp_f32 v38, v38
    v_exp_f32 v39, v39
    v_exp_f32 v40, v40
    v_mfma_f32_32x32x16_bf16 v[52:67], v[24:27], v[20:23], 0
    ds_read_b128 v[24:27], v2 offset:31680
    v_exp_f32 v41, v41
    v_exp_f32 v42, v42
    v_exp_f32 v43, v43
    v_exp_f32 v44, v44
    v_exp_f32 v45, v45
    v_smfmac_f32_32x32x32_bf16 v[68:83], v[28:31], v[36:43], v1
    s_waitcnt lgkmcnt(1)
    buffer_load_dwordx4 a[208:211], v8, s[12:15], s70 offen offset:2048 sc1
    v_exp_f32 v46, v46
    v_exp_f32 v47, v47
    v_exp_f32 v48, v48
    v_exp_f32 v49, v49
    v_exp_f32 v50, v50
    v_exp_f32 v51, v51
    v_exp_f32 v52, v52
    v_exp_f32 v53, v53
    v_smfmac_f32_32x32x32_bf16 v[68:83], v[32:35], v[44:51], v1
    s_waitcnt lgkmcnt(0)
    s_mov_b32 exec_lo, 0
    s_mov_b32 exec_hi, 1044480
    buffer_load_dword v14, v128, s[20:23], 0 offen sc1
    s_mov_b64 exec, -1
    v_exp_f32 v54, v54
    v_exp_f32 v55, v55
    v_exp_f32 v56, v56
    v_mfma_f32_32x32x16_bf16 v[36:51], v[24:27], v[16:19], 0
    buffer_load_dwordx4 a[212:215], v9, s[12:15], s70 offen offset:2048 sc1
    v_exp_f32 v57, v57
    v_exp_f32 v58, v58
    v_exp_f32 v59, v59
    v_exp_f32 v60, v60
    v_exp_f32 v61, v61
    v_smfmac_f32_32x32x32_bf16 v[84:99], v[28:31], v[52:59], v1
    ds_read_b128 v[28:31], v5 offset:31680
    v_exp_f32 v62, v62
    v_exp_f32 v63, v63
    v_exp_f32 v64, v64
    v_exp_f32 v65, v65
    v_exp_f32 v66, v66
    v_exp_f32 v67, v67
    v_exp_f32 v36, v36
    v_exp_f32 v37, v37
    v_smfmac_f32_32x32x32_bf16 v[84:99], v[32:35], v[60:67], v1
    s_waitcnt lgkmcnt(0)
    ds_read_b128 v[32:35], v5 offset:32224
    v_exp_f32 v38, v38
    v_exp_f32 v39, v39
    v_exp_f32 v40, v40
    v_mfma_f32_32x32x16_bf16 v[52:67], v[24:27], v[20:23], 0
    ds_read_b128 v[24:27], v2 offset:33792
    v_exp_f32 v41, v41
    v_exp_f32 v42, v42
    v_exp_f32 v43, v43
    v_exp_f32 v44, v44
    v_exp_f32 v45, v45
    v_smfmac_f32_32x32x32_bf16 v[68:83], v[28:31], v[36:43], v1
    s_waitcnt lgkmcnt(1)
    buffer_load_dwordx4 a[216:219], v8, s[12:15], s70 offen offset:3072 sc1
    v_exp_f32 v46, v46
    v_exp_f32 v47, v47
    v_exp_f32 v48, v48
    v_exp_f32 v49, v49
    v_exp_f32 v50, v50
    v_exp_f32 v51, v51
    v_exp_f32 v52, v52
    v_exp_f32 v53, v53
    v_smfmac_f32_32x32x32_bf16 v[68:83], v[32:35], v[44:51], v1
    s_waitcnt lgkmcnt(0)
    buffer_load_dwordx4 a[220:223], v9, s[12:15], s70 offen offset:3072 sc1
    v_exp_f32 v54, v54
    v_exp_f32 v55, v55
    v_exp_f32 v56, v56
    v_mfma_f32_32x32x16_bf16 v[36:51], v[24:27], v[16:19], 0
    buffer_load_dwordx4 a[224:227], v8, s[12:15], s71 offen offset:0 sc1
    v_exp_f32 v57, v57
    v_exp_f32 v58, v58
    v_exp_f32 v59, v59
    v_exp_f32 v60, v60
    v_exp_f32 v61, v61
    v_smfmac_f32_32x32x32_bf16 v[84:99], v[28:31], v[52:59], v1
    ds_read_b128 v[28:31], v5 offset:33792
    v_exp_f32 v62, v62
    v_exp_f32 v63, v63
    v_exp_f32 v64, v64
    v_exp_f32 v65, v65
    v_exp_f32 v66, v66
    v_exp_f32 v67, v67
    v_exp_f32 v36, v36
    v_exp_f32 v37, v37
    v_smfmac_f32_32x32x32_bf16 v[84:99], v[32:35], v[60:67], v1
    s_waitcnt lgkmcnt(0)
    ds_read_b128 v[32:35], v5 offset:34336
    v_exp_f32 v38, v38
    v_exp_f32 v39, v39
    v_exp_f32 v40, v40
    v_mfma_f32_32x32x16_bf16 v[52:67], v[24:27], v[20:23], 0
    ds_read_b128 v[24:27], v2 offset:35904
    v_exp_f32 v41, v41
    v_exp_f32 v42, v42
    v_exp_f32 v43, v43
    v_exp_f32 v44, v44
    v_exp_f32 v45, v45
    v_smfmac_f32_32x32x32_bf16 v[68:83], v[28:31], v[36:43], v1
    s_waitcnt lgkmcnt(1)
    buffer_load_dwordx4 a[228:231], v9, s[12:15], s71 offen offset:0 sc1
    v_exp_f32 v46, v46
    v_exp_f32 v47, v47
    v_exp_f32 v48, v48
    v_exp_f32 v49, v49
    v_exp_f32 v50, v50
    v_exp_f32 v51, v51
    v_exp_f32 v52, v52
    v_exp_f32 v53, v53
    v_smfmac_f32_32x32x32_bf16 v[68:83], v[32:35], v[44:51], v1
    s_waitcnt lgkmcnt(0)
    buffer_load_dwordx4 a[232:235], v8, s[12:15], s71 offen offset:1024 sc1
    v_exp_f32 v54, v54
    v_exp_f32 v55, v55
    v_exp_f32 v56, v56
    v_mfma_f32_32x32x16_bf16 v[36:51], v[24:27], v[16:19], 0
    buffer_load_dwordx4 a[236:239], v9, s[12:15], s71 offen offset:1024 sc1
    v_exp_f32 v57, v57
    v_exp_f32 v58, v58
    v_exp_f32 v59, v59
    v_exp_f32 v60, v60
    v_exp_f32 v61, v61
    v_smfmac_f32_32x32x32_bf16 v[84:99], v[28:31], v[52:59], v1
    ds_read_b128 v[28:31], v5 offset:35904
    v_exp_f32 v62, v62
    v_exp_f32 v63, v63
    v_exp_f32 v64, v64
    v_exp_f32 v65, v65
    v_exp_f32 v66, v66
    v_exp_f32 v67, v67
    v_exp_f32 v36, v36
    v_exp_f32 v37, v37
    v_smfmac_f32_32x32x32_bf16 v[84:99], v[32:35], v[60:67], v1
    s_waitcnt lgkmcnt(0)
    ds_read_b128 v[32:35], v5 offset:36448
    v_exp_f32 v38, v38
    v_exp_f32 v39, v39
    v_exp_f32 v40, v40
    v_mfma_f32_32x32x16_bf16 v[52:67], v[24:27], v[20:23], 0
    ds_read_b128 v[24:27], v2 offset:38016
    v_exp_f32 v41, v41
    v_exp_f32 v42, v42
    v_exp_f32 v43, v43
    v_exp_f32 v44, v44
    v_exp_f32 v45, v45
    v_smfmac_f32_32x32x32_bf16 v[68:83], v[28:31], v[36:43], v1
    s_waitcnt lgkmcnt(1)
    buffer_load_dwordx4 a[240:243], v8, s[12:15], s71 offen offset:2048 sc1
    v_exp_f32 v46, v46
    v_exp_f32 v47, v47
    v_exp_f32 v48, v48
    v_exp_f32 v49, v49
    v_exp_f32 v50, v50
    v_exp_f32 v51, v51
    v_exp_f32 v52, v52
    v_exp_f32 v53, v53
    v_smfmac_f32_32x32x32_bf16 v[68:83], v[32:35], v[44:51], v1
    s_waitcnt lgkmcnt(0)
    buffer_load_dwordx4 a[244:247], v9, s[12:15], s71 offen offset:2048 sc1
    v_exp_f32 v54, v54
    v_exp_f32 v55, v55
    v_exp_f32 v56, v56
    v_mfma_f32_32x32x16_bf16 v[36:51], v[24:27], v[16:19], 0
    buffer_load_dwordx4 a[248:251], v8, s[12:15], s71 offen offset:3072 sc1
    v_exp_f32 v57, v57
    v_exp_f32 v58, v58
    v_exp_f32 v59, v59
    v_exp_f32 v60, v60
    v_exp_f32 v61, v61
    v_smfmac_f32_32x32x32_bf16 v[84:99], v[28:31], v[52:59], v1
    ds_read_b128 v[28:31], v5 offset:38016
    v_exp_f32 v62, v62
    v_exp_f32 v63, v63
    v_exp_f32 v64, v64
    v_exp_f32 v65, v65
    v_exp_f32 v66, v66
    v_exp_f32 v67, v67
    v_exp_f32 v36, v36
    v_exp_f32 v37, v37
    v_smfmac_f32_32x32x32_bf16 v[84:99], v[32:35], v[60:67], v1
    s_waitcnt lgkmcnt(0)
    ds_read_b128 v[32:35], v5 offset:38560
    v_exp_f32 v38, v38
    v_exp_f32 v39, v39
    v_exp_f32 v40, v40
    v_mfma_f32_32x32x16_bf16 v[52:67], v[24:27], v[20:23], 0
    ds_read_b128 v[24:27], v2 offset:40128
    v_exp_f32 v41, v41
    v_exp_f32 v42, v42
    v_exp_f32 v43, v43
    v_exp_f32 v44, v44
    v_exp_f32 v45, v45
    v_smfmac_f32_32x32x32_bf16 v[68:83], v[28:31], v[36:43], v1
    s_waitcnt lgkmcnt(1)
    buffer_load_dwordx4 a[252:255], v9, s[12:15], s71 offen offset:3072 sc1
    v_exp_f32 v46, v46
    v_exp_f32 v47, v47
    v_exp_f32 v48, v48
    v_exp_f32 v49, v49
    v_exp_f32 v50, v50
    v_exp_f32 v51, v51
    v_exp_f32 v52, v52
    v_exp_f32 v53, v53
    v_smfmac_f32_32x32x32_bf16 v[68:83], v[32:35], v[44:51], v1
    s_waitcnt lgkmcnt(0)
    buffer_load_dwordx4 v[224:227], v157, s[20:23], s40 offen offset:1024 sc1
    v_exp_f32 v54, v54
    v_exp_f32 v55, v55
    v_exp_f32 v56, v56
    v_mfma_f32_32x32x16_bf16 v[36:51], v[24:27], v[16:19], 0
    buffer_load_dwordx4 v[228:231], v157, s[20:23], s40 offen offset:3072 sc1
    v_exp_f32 v57, v57
    v_exp_f32 v58, v58
    v_exp_f32 v59, v59
    v_exp_f32 v60, v60
    v_exp_f32 v61, v61
    v_smfmac_f32_32x32x32_bf16 v[84:99], v[28:31], v[52:59], v1
    ds_read_b128 v[28:31], v5 offset:40128
    v_exp_f32 v62, v62
    v_exp_f32 v63, v63
    v_exp_f32 v64, v64
    v_exp_f32 v65, v65
    v_exp_f32 v66, v66
    v_exp_f32 v67, v67
    v_exp_f32 v36, v36
    v_exp_f32 v37, v37
    v_smfmac_f32_32x32x32_bf16 v[84:99], v[32:35], v[60:67], v1
    s_waitcnt lgkmcnt(0)
    ds_read_b128 v[32:35], v5 offset:40672
    v_exp_f32 v38, v38
    v_exp_f32 v39, v39
    v_exp_f32 v40, v40
    v_mfma_f32_32x32x16_bf16 v[52:67], v[24:27], v[20:23], 0
    ds_read_b128 v[24:27], v2 offset:42240
    v_exp_f32 v41, v41
    v_exp_f32 v42, v42
    v_exp_f32 v43, v43
    v_exp_f32 v44, v44
    v_exp_f32 v45, v45
    v_smfmac_f32_32x32x32_bf16 v[68:83], v[28:31], v[36:43], v1
    s_waitcnt lgkmcnt(1)
    buffer_load_dwordx4 v[232:235], v157, s[20:23], s41 offen offset:1024 sc1
    v_exp_f32 v46, v46
    v_exp_f32 v47, v47
    v_exp_f32 v48, v48
    v_exp_f32 v49, v49
    v_exp_f32 v50, v50
    v_exp_f32 v51, v51
    v_exp_f32 v52, v52
    v_exp_f32 v53, v53
    v_smfmac_f32_32x32x32_bf16 v[68:83], v[32:35], v[44:51], v1
    s_waitcnt lgkmcnt(0)
    s_mov_b32 exec_lo, 65535
    s_mov_b32 exec_hi, 4278190080
    buffer_load_dword v14, v128, s[20:23], 0 offen sc1
    s_mov_b64 exec, -1
    v_exp_f32 v54, v54
    v_exp_f32 v55, v55
    v_exp_f32 v56, v56
    v_mfma_f32_32x32x16_bf16 v[36:51], v[24:27], v[16:19], 0
    buffer_load_dwordx4 v[236:239], v157, s[20:23], s41 offen offset:3072 sc1
    v_exp_f32 v57, v57
    v_exp_f32 v58, v58
    v_exp_f32 v59, v59
    v_exp_f32 v60, v60
    v_exp_f32 v61, v61
    v_smfmac_f32_32x32x32_bf16 v[84:99], v[28:31], v[52:59], v1
    ds_read_b128 v[28:31], v5 offset:42240
    v_exp_f32 v62, v62
    v_exp_f32 v63, v63
    v_exp_f32 v64, v64
    v_exp_f32 v65, v65
    v_exp_f32 v66, v66
    v_exp_f32 v67, v67
    v_exp_f32 v36, v36
    v_exp_f32 v37, v37
    v_smfmac_f32_32x32x32_bf16 v[84:99], v[32:35], v[60:67], v1
    s_waitcnt lgkmcnt(0)
    ds_read_b128 v[32:35], v5 offset:42784
    v_exp_f32 v38, v38
    v_exp_f32 v39, v39
    v_exp_f32 v40, v40
    v_mfma_f32_32x32x16_bf16 v[52:67], v[24:27], v[20:23], 0
    ds_read_b128 v[24:27], v2 offset:44352
    v_exp_f32 v41, v41
    v_exp_f32 v42, v42
    v_exp_f32 v43, v43
    v_exp_f32 v44, v44
    v_exp_f32 v45, v45
    v_smfmac_f32_32x32x32_bf16 v[68:83], v[28:31], v[36:43], v1
    s_waitcnt lgkmcnt(1)
    buffer_load_dwordx4 v[240:243], v157, s[20:23], s42 offen offset:1024 sc1
    v_exp_f32 v46, v46
    v_exp_f32 v47, v47
    v_exp_f32 v48, v48
    v_exp_f32 v49, v49
    v_exp_f32 v50, v50
    v_exp_f32 v51, v51
    v_exp_f32 v52, v52
    v_exp_f32 v53, v53
    v_smfmac_f32_32x32x32_bf16 v[68:83], v[32:35], v[44:51], v1
    s_waitcnt lgkmcnt(0)
    buffer_load_dwordx4 v[244:247], v157, s[20:23], s42 offen offset:3072 sc1
    v_exp_f32 v54, v54
    v_exp_f32 v55, v55
    v_exp_f32 v56, v56
    v_mfma_f32_32x32x16_bf16 v[36:51], v[24:27], v[16:19], 0
    buffer_load_dwordx4 v[248:251], v157, s[20:23], s43 offen offset:1024 sc1
    v_exp_f32 v57, v57
    v_exp_f32 v58, v58
    v_exp_f32 v59, v59
    v_exp_f32 v60, v60
    v_exp_f32 v61, v61
    v_smfmac_f32_32x32x32_bf16 v[84:99], v[28:31], v[52:59], v1
    ds_read_b128 v[28:31], v5 offset:44352
    v_exp_f32 v62, v62
    v_exp_f32 v63, v63
    v_exp_f32 v64, v64
    v_exp_f32 v65, v65
    v_exp_f32 v66, v66
    v_exp_f32 v67, v67
    v_exp_f32 v36, v36
    v_exp_f32 v37, v37
    v_smfmac_f32_32x32x32_bf16 v[84:99], v[32:35], v[60:67], v1
    s_waitcnt lgkmcnt(0)
    ds_read_b128 v[32:35], v5 offset:44896
    v_exp_f32 v38, v38
    v_exp_f32 v39, v39
    v_exp_f32 v40, v40
    v_mfma_f32_32x32x16_bf16 v[52:67], v[24:27], v[20:23], 0
    ds_read_b128 v[24:27], v2 offset:46464
    v_exp_f32 v41, v41
    v_exp_f32 v42, v42
    v_exp_f32 v43, v43
    v_exp_f32 v44, v44
    v_exp_f32 v45, v45
    v_smfmac_f32_32x32x32_bf16 v[68:83], v[28:31], v[36:43], v1
    s_waitcnt lgkmcnt(1)
    buffer_load_dwordx4 v[252:255], v157, s[20:23], s43 offen offset:3072 sc1
    v_exp_f32 v46, v46
    v_exp_f32 v47, v47
    v_exp_f32 v48, v48
    v_exp_f32 v49, v49
    v_exp_f32 v50, v50
    v_exp_f32 v51, v51
    v_exp_f32 v52, v52
    v_exp_f32 v53, v53
    v_smfmac_f32_32x32x32_bf16 v[68:83], v[32:35], v[44:51], v1
    s_waitcnt lgkmcnt(0)
    v_exp_f32 v54, v54
    v_exp_f32 v55, v55
    v_exp_f32 v56, v56
    v_mfma_f32_32x32x16_bf16 v[36:51], v[24:27], v[16:19], 0
    ds_read_b128 v[24:27], v2 offset:48576
    s_add_u32 m0, s63, 2048
    s_nop 0
    buffer_load_dwordx4 v157, s[20:23], s40 offen offset:0 sc1 lds
    v_exp_f32 v57, v57
    v_exp_f32 v58, v58
    v_exp_f32 v59, v59
    v_exp_f32 v60, v60
    v_exp_f32 v61, v61
    v_smfmac_f32_32x32x32_bf16 v[84:99], v[28:31], v[52:59], v1
    ds_read_b128 v[140:143], v5 offset:47008
    ds_read_b128 v[28:31], v5 offset:46464
    v_exp_f32 v62, v62
    v_exp_f32 v63, v63
    v_exp_f32 v64, v64
    v_exp_f32 v65, v65
    v_exp_f32 v66, v66
    v_exp_f32 v67, v67
    v_exp_f32 v36, v36
    v_exp_f32 v37, v37
    v_smfmac_f32_32x32x32_bf16 v[84:99], v[32:35], v[60:67], v1
    s_waitcnt lgkmcnt(2)
    v_exp_f32 v38, v38
    v_exp_f32 v39, v39
    v_exp_f32 v40, v40
    v_mfma_f32_32x32x16_bf16 v[52:67], v[24:27], v[16:19], 0
    ds_read_b128 v[24:27], v2 offset:50688
    s_waitcnt lgkmcnt(1)
    v_exp_f32 v41, v41
    v_exp_f32 v42, v42
    v_exp_f32 v43, v43
    v_exp_f32 v44, v44
    v_exp_f32 v45, v45
    v_smfmac_f32_32x32x32_bf16 v[68:83], v[28:31], v[36:43], v1
    ds_read_b128 v[32:35], v5 offset:49120
    ds_read_b128 v[28:31], v5 offset:48576
    s_add_u32 m0, s63, 1024
    s_nop 0
    buffer_load_dwordx4 v157, s[20:23], s40 offen offset:2048 sc1 lds
    v_exp_f32 v46, v46
    v_exp_f32 v47, v47
    v_exp_f32 v48, v48
    v_exp_f32 v49, v49
    v_exp_f32 v50, v50
    v_exp_f32 v51, v51
    v_exp_f32 v52, v52
    v_exp_f32 v53, v53
    v_smfmac_f32_32x32x32_bf16 v[68:83], v[140:143], v[44:51], v1
    s_waitcnt lgkmcnt(2)
    s_add_u32 m0, s63, 4096
    s_nop 0
    buffer_load_dwordx4 v157, s[20:23], s41 offen offset:0 sc1 lds
    v_exp_f32 v54, v54
    v_exp_f32 v55, v55
    v_exp_f32 v56, v56
    v_mfma_f32_32x32x16_bf16 v[36:51], v[24:27], v[16:19], 0
    ds_read_b128 v[24:27], v2 offset:52800
    s_waitcnt lgkmcnt(1)
    s_add_u32 m0, s63, 3072
    s_nop 0
    buffer_load_dwordx4 v157, s[20:23], s41 offen offset:2048 sc1 lds
    v_exp_f32 v57, v57
    v_exp_f32 v58, v58
    v_exp_f32 v59, v59
    v_exp_f32 v60, v60
    v_exp_f32 v61, v61
    v_smfmac_f32_32x32x32_bf16 v[68:83], v[28:31], v[52:59], v1
    ds_read_b128 v[140:143], v5 offset:51232
    ds_read_b128 v[28:31], v5 offset:50688
    v_exp_f32 v62, v62
    v_exp_f32 v63, v63
    v_exp_f32 v64, v64
    v_exp_f32 v65, v65
    v_exp_f32 v66, v66
    v_exp_f32 v67, v67
    v_exp_f32 v36, v36
    v_exp_f32 v37, v37
    v_smfmac_f32_32x32x32_bf16 v[68:83], v[32:35], v[60:67], v1
    s_waitcnt lgkmcnt(2)
    v_exp_f32 v38, v38
    v_exp_f32 v39, v39
    v_exp_f32 v40, v40
    v_mfma_f32_32x32x16_bf16 v[52:67], v[24:27], v[16:19], 0
    ds_read_b128 v[24:27], v2 offset:54912
    s_waitcnt lgkmcnt(1)
    v_exp_f32 v41, v41
    v_exp_f32 v42, v42
    v_exp_f32 v43, v43
    v_exp_f32 v44, v44
    v_exp_f32 v45, v45
    v_smfmac_f32_32x32x32_bf16 v[68:83], v[28:31], v[36:43], v1
    ds_read_b128 v[32:35], v5 offset:53344
    ds_read_b128 v[28:31], v5 offset:52800
    s_add_u32 m0, s63, 6144
    s_nop 0
    buffer_load_dwordx4 v157, s[20:23], s42 offen offset:0 sc1 lds
    v_exp_f32 v46, v46
    v_exp_f32 v47, v47
    v_exp_f32 v48, v48
    v_exp_f32 v49, v49
    v_exp_f32 v50, v50
    v_exp_f32 v51, v51
    v_exp_f32 v52, v52
    v_exp_f32 v53, v53
    v_smfmac_f32_32x32x32_bf16 v[68:83], v[140:143], v[44:51], v1
    s_waitcnt lgkmcnt(2)
    s_add_u32 m0, s63, 5120
    s_nop 0
    buffer_load_dwordx4 v157, s[20:23], s42 offen offset:2048 sc1 lds
    v_exp_f32 v54, v54
    v_exp_f32 v55, v55
    v_exp_f32 v56, v56
    v_mfma_f32_32x32x16_bf16 v[36:51], v[24:27], v[16:19], 0
    ds_read_b128 v[24:27], v2 offset:57024
    s_waitcnt lgkmcnt(1)
    s_add_u32 m0, s63, 8192
    s_nop 0
    buffer_load_dwordx4 v157, s[20:23], s43 offen offset:0 sc1 lds
    v_exp_f32 v57, v57
    v_exp_f32 v58, v58
    v_exp_f32 v59, v59
    v_exp_f32 v60, v60
    v_exp_f32 v61, v61
    v_smfmac_f32_32x32x32_bf16 v[68:83], v[28:31], v[52:59], v1
    ds_read_b128 v[140:143], v5 offset:55456
    ds_read_b128 v[28:31], v5 offset:54912
    v_exp_f32 v62, v62
    v_exp_f32 v63, v63
    v_exp_f32 v64, v64
    v_exp_f32 v65, v65
    v_exp_f32 v66, v66
    v_exp_f32 v67, v67
    v_exp_f32 v36, v36
    v_exp_f32 v37, v37
    v_smfmac_f32_32x32x32_bf16 v[68:83], v[32:35], v[60:67], v1
    s_waitcnt lgkmcnt(2)
    v_exp_f32 v38, v38
    v_exp_f32 v39, v39
    v_exp_f32 v40, v40
    v_mfma_f32_32x32x16_bf16 v[52:67], v[24:27], v[16:19], 0
    ds_read_b128 v[24:27], v2 offset:59136
    s_waitcnt lgkmcnt(1)
    v_exp_f32 v41, v41
    v_exp_f32 v42, v42
    v_exp_f32 v43, v43
    v_exp_f32 v44, v44
    v_exp_f32 v45, v45
    v_smfmac_f32_32x32x32_bf16 v[68:83], v[28:31], v[36:43], v1
    ds_read_b128 v[32:35], v5 offset:57568
    ds_read_b128 v[28:31], v5 offset:57024
    s_add_u32 m0, s63, 7168
    s_nop 0
    buffer_load_dwordx4 v157, s[20:23], s43 offen offset:2048 sc1 lds
    v_exp_f32 v46, v46
    v_exp_f32 v47, v47
    v_exp_f32 v48, v48
    v_exp_f32 v49, v49
    v_exp_f32 v50, v50
    v_exp_f32 v51, v51
    v_exp_f32 v52, v52
    v_exp_f32 v53, v53
    v_smfmac_f32_32x32x32_bf16 v[68:83], v[140:143], v[44:51], v1
    s_waitcnt lgkmcnt(2)
    s_mov_b32 exec_lo, 4294901760
    s_mov_b32 exec_hi, 15728640
    buffer_load_dword v14, v128, s[20:23], 0 offen sc1
    s_mov_b64 exec, -1
    v_exp_f32 v54, v54
    v_exp_f32 v55, v55
    v_exp_f32 v56, v56
    v_mfma_f32_32x32x16_bf16 v[36:51], v[24:27], v[16:19], 0
    ds_read_b128 v[24:27], v2 offset:61248
    s_waitcnt lgkmcnt(1)
    s_add_u32 m0, s63, 10240
    s_nop 0
    buffer_load_dwordx4 v157, s[20:23], s44 offen offset:0 sc1 lds
    v_exp_f32 v57, v57
    v_exp_f32 v58, v58
    v_exp_f32 v59, v59
    v_exp_f32 v60, v60
    v_exp_f32 v61, v61
    v_smfmac_f32_32x32x32_bf16 v[68:83], v[28:31], v[52:59], v1
    ds_read_b128 v[140:143], v5 offset:59680
    ds_read_b128 v[28:31], v5 offset:59136
    v_exp_f32 v62, v62
    v_exp_f32 v63, v63
    v_exp_f32 v64, v64
    v_exp_f32 v65, v65
    v_exp_f32 v66, v66
    v_exp_f32 v67, v67
    v_exp_f32 v36, v36
    v_exp_f32 v37, v37
    v_smfmac_f32_32x32x32_bf16 v[68:83], v[32:35], v[60:67], v1
    s_waitcnt lgkmcnt(2)
    v_exp_f32 v38, v38
    v_exp_f32 v39, v39
    v_exp_f32 v40, v40
    v_mfma_f32_32x32x16_bf16 v[52:67], v[24:27], v[16:19], 0
    ds_read_b128 v[24:27], v2 offset:63360
    s_waitcnt lgkmcnt(1)
    v_exp_f32 v41, v41
    v_exp_f32 v42, v42
    v_exp_f32 v43, v43
    v_exp_f32 v44, v44
    v_exp_f32 v45, v45
    v_smfmac_f32_32x32x32_bf16 v[68:83], v[28:31], v[36:43], v1
    ds_read_b128 v[32:35], v5 offset:61792
    ds_read_b128 v[28:31], v5 offset:61248
    s_add_u32 m0, s63, 9216
    s_nop 0
    buffer_load_dwordx4 v157, s[20:23], s44 offen offset:2048 sc1 lds
    v_exp_f32 v46, v46
    v_exp_f32 v47, v47
    v_exp_f32 v48, v48
    v_exp_f32 v49, v49
    v_exp_f32 v50, v50
    v_exp_f32 v51, v51
    v_exp_f32 v52, v52
    v_exp_f32 v53, v53
    v_smfmac_f32_32x32x32_bf16 v[68:83], v[140:143], v[44:51], v1
    s_waitcnt lgkmcnt(2)
    s_add_u32 m0, s63, 12288
    s_nop 0
    buffer_load_dwordx4 v157, s[20:23], s45 offen offset:0 sc1 lds
    v_exp_f32 v54, v54
    v_exp_f32 v55, v55
    v_exp_f32 v56, v56
    v_mfma_f32_32x32x16_bf16 v[36:51], v[24:27], v[16:19], 0
    ds_read_b128 v[24:27], v3 offset:0
    s_waitcnt lgkmcnt(1)
    s_add_u32 m0, s63, 11264
    s_nop 0
    buffer_load_dwordx4 v157, s[20:23], s45 offen offset:2048 sc1 lds
    v_exp_f32 v57, v57
    v_exp_f32 v58, v58
    v_exp_f32 v59, v59
    v_exp_f32 v60, v60
    v_exp_f32 v61, v61
    v_smfmac_f32_32x32x32_bf16 v[68:83], v[28:31], v[52:59], v1
    ds_read_b128 v[140:143], v5 offset:63904
    ds_read_b128 v[28:31], v5 offset:63360
    v_exp_f32 v62, v62
    v_exp_f32 v63, v63
    v_exp_f32 v64, v64
    v_exp_f32 v65, v65
    v_exp_f32 v66, v66
    v_exp_f32 v67, v67
    v_exp_f32 v36, v36
    v_exp_f32 v37, v37
    v_smfmac_f32_32x32x32_bf16 v[68:83], v[32:35], v[60:67], v1
    s_waitcnt lgkmcnt(2)
    v_exp_f32 v38, v38
    v_exp_f32 v39, v39
    v_exp_f32 v40, v40
    v_mfma_f32_32x32x16_bf16 v[52:67], v[24:27], v[16:19], 0
    ds_read_b128 v[24:27], v2 offset:46464
    s_waitcnt lgkmcnt(1)
    v_exp_f32 v41, v41
    v_exp_f32 v42, v42
    v_exp_f32 v43, v43
    v_exp_f32 v44, v44
    v_exp_f32 v45, v45
    v_smfmac_f32_32x32x32_bf16 v[68:83], v[28:31], v[36:43], v1
    ds_read_b128 v[32:35], v6 offset:544
    ds_read_b128 v[28:31], v6 offset:0
    s_add_u32 m0, s63, 14336
    s_nop 0
    buffer_load_dwordx4 v157, s[20:23], s46 offen offset:0 sc1 lds
    v_exp_f32 v46, v46
    v_exp_f32 v47, v47
    v_exp_f32 v48, v48
    v_exp_f32 v49, v49
    v_exp_f32 v50, v50
    v_exp_f32 v51, v51
    v_exp_f32 v52, v52
    v_exp_f32 v53, v53
    v_smfmac_f32_32x32x32_bf16 v[68:83], v[140:143], v[44:51], v1
    s_waitcnt lgkmcnt(2)
    s_add_u32 m0, s63, 13312
    s_nop 0
    buffer_load_dwordx4 v157, s[20:23], s46 offen offset:2048 sc1 lds
    v_exp_f32 v54, v54
    v_exp_f32 v55, v55
    v_exp_f32 v56, v56
    v_mfma_f32_32x32x16_bf16 v[36:51], v[24:27], v[20:23], 0
    ds_read_b128 v[24:27], v2 offset:48576
    s_waitcnt lgkmcnt(1)
    s_add_u32 m0, s63, 16384
    s_nop 0
    buffer_load_dwordx4 v157, s[20:23], s47 offen offset:0 sc1 lds
    v_exp_f32 v57, v57
    v_exp_f32 v58, v58
    v_exp_f32 v59, v59
    v_exp_f32 v60, v60
    v_exp_f32 v61, v61
    v_smfmac_f32_32x32x32_bf16 v[68:83], v[28:31], v[52:59], v1
    ds_read_b128 v[140:143], v5 offset:47008
    ds_read_b128 v[28:31], v5 offset:46464
    v_exp_f32 v62, v62
    v_exp_f32 v63, v63
    v_exp_f32 v64, v64
    v_exp_f32 v65, v65
    v_exp_f32 v66, v66
    v_exp_f32 v67, v67
    v_exp_f32 v36, v36
    v_exp_f32 v37, v37
    v_smfmac_f32_32x32x32_bf16 v[68:83], v[32:35], v[60:67], v1
    s_waitcnt lgkmcnt(2)
    v_exp_f32 v38, v38
    v_exp_f32 v39, v39
    v_exp_f32 v40, v40
    v_mfma_f32_32x32x16_bf16 v[52:67], v[24:27], v[20:23], 0
    ds_read_b128 v[24:27], v2 offset:50688
    s_waitcnt lgkmcnt(1)
    v_exp_f32 v41, v41
    v_exp_f32 v42, v42
    v_exp_f32 v43, v43
    v_exp_f32 v44, v44
    v_exp_f32 v45, v45
    v_smfmac_f32_32x32x32_bf16 v[84:99], v[28:31], v[36:43], v1
    ds_read_b128 v[32:35], v5 offset:49120
    ds_read_b128 v[28:31], v5 offset:48576
    s_add_u32 m0, s63, 15360
    s_nop 0
    buffer_load_dwordx4 v157, s[20:23], s47 offen offset:2048 sc1 lds
    v_exp_f32 v46, v46
    v_exp_f32 v47, v47
    v_exp_f32 v48, v48
    v_exp_f32 v49, v49
    v_exp_f32 v50, v50
    v_exp_f32 v51, v51
    v_exp_f32 v52, v52
    v_exp_f32 v53, v53
    v_smfmac_f32_32x32x32_bf16 v[84:99], v[140:143], v[44:51], v1
    s_waitcnt lgkmcnt(2)
    s_add_u32 m0, s63, 18432
    s_nop 0
    buffer_load_dwordx4 v157, s[20:23], s48 offen offset:0 sc1 lds
    s_mov_b32 s94, 0x21800000
    s_mov_b32 s95, 0x5d800000
    v_exp_f32 v54, v54
    v_exp_f32 v55, v55
    v_pk_mul_f32 v[10:11], v[68:69], 0
    v_pk_fma_f32 v[10:11], v[70:71], 0, v[10:11]
    v_pk_fma_f32 v[10:11], v[72:73], 0, v[10:11]
    v_pk_fma_f32 v[10:11], v[74:75], 0, v[10:11]
    v_exp_f32 v56, v56
    v_mfma_f32_32x32x16_bf16 v[36:51], v[24:27], v[20:23], 0
    ds_read_b128 v[24:27], v2 offset:52800
    s_waitcnt lgkmcnt(1)
    s_add_u32 m0, s63, 17408
    s_nop 0
    buffer_load_dwordx4 v157, s[20:23], s48 offen offset:2048 sc1 lds
    v_exp_f32 v57, v57
    v_exp_f32 v58, v58
    v_exp_f32 v59, v59
    v_exp_f32 v60, v60
    v_add_f32 v10, v10, v11
    v_add_f32 v11, v10, v76
    v_cmp_le_f32 vcc, s94, v11
    v_cmp_ge_f32 s[86:87], s95, v11
    v_exp_f32 v61, v61
    v_smfmac_f32_32x32x32_bf16 v[84:99], v[28:31], v[52:59], v1
    ds_read_b128 v[140:143], v5 offset:51232
    ds_read_b128 v[28:31], v5 offset:50688
    s_and_b64 vcc, vcc, s[86:87]
    s_cmp_eq_u64 vcc, -1
    s_cselect_b64 s[100:101], -1, 0
    v_exp_f32 v62, v62
    v_exp_f32 v63, v63
    v_exp_f32 v64, v64
    v_exp_f32 v65, v65
    v_exp_f32 v66, v66
    v_exp_f32 v67, v67
    v_exp_f32 v36, v36
    v_rcp_f32 v10, v76
    s_nop 0
    v_pk_mul_f32 v[68:69], v[68:69], v[10:11] op_sel_hi:[1,0]
    v_pk_mul_f32 v[70:71], v[70:71], v[10:11] op_sel_hi:[1,0]
    v_pk_mul_f32 v[72:73], v[72:73], v[10:11] op_sel_hi:[1,0]
    v_exp_f32 v37, v37
    v_smfmac_f32_32x32x32_bf16 v[84:99], v[32:35], v[60:67], v1
    s_waitcnt lgkmcnt(2)
    v_exp_f32 v38, v38
    v_exp_f32 v39, v39
    v_pk_mul_f32 v[74:75], v[74:75], v[10:11] op_sel_hi:[1,0]
    v_cvt_pk_bf16_f32 v68, v68, v69
    v_cvt_pk_bf16_f32 v69, v70, v71
    v_cvt_pk_bf16_f32 v70, v72, v73
    v_exp_f32 v40, v40
    v_mfma_f32_32x32x16_bf16 v[52:67], v[24:27], v[20:23], 0
    ds_read_b128 v[24:27], v2 offset:54912
    s_waitcnt lgkmcnt(1)
    v_exp_f32 v41, v41
    v_exp_f32 v42, v42
    v_exp_f32 v43, v43
    v_exp_f32 v44, v44
    v_cvt_pk_bf16_f32 v71, v74, v75
    v_mov_b32 v10, s39
    v_exp_f32 v45, v45
    v_smfmac_f32_32x32x32_bf16 v[84:99], v[28:31], v[36:43], v1
    ds_read_b128 v[32:35], v5 offset:53344
    ds_read_b128 v[28:31], v5 offset:52800
    s_add_u32 m0, s63, 20480
    s_nop 0
    buffer_load_dwordx4 v157, s[20:23], s49 offen offset:0 sc1 lds
    s_cmp_eq_u32 s85, 0
    s_cbranch_scc1 L_alt5
    s_mov_b64 exec, s[100:101]
    buffer_store_dwordx4 v[68:71], v8, s[32:35], s93 offen
    s_mov_b64 exec, -1
L_join6:
    v_exp_f32 v46, v46
    v_exp_f32 v47, v47
    v_exp_f32 v48, v48
    v_exp_f32 v49, v49
    v_exp_f32 v50, v50
    v_exp_f32 v51, v51
    v_exp_f32 v52, v52
    v_exp_f32 v53, v53
    v_smfmac_f32_32x32x32_bf16 v[84:99], v[140:143], v[44:51], v1
    s_waitcnt lgkmcnt(2)
    s_add_u32 m0, s63, 19456
    s_nop 0
    buffer_load_dwordx4 v157, s[20:23], s49 offen offset:2048 sc1 lds
    v_exp_f32 v54, v54
    v_exp_f32 v55, v55
    v_exp_f32 v56, v56
    v_mfma_f32_32x32x16_bf16 v[36:51], v[24:27], v[20:23], 0
    ds_read_b128 v[24:27], v2 offset:57024
    s_waitcnt lgkmcnt(1)
    s_add_u32 m0, s63, 22528
    s_nop 0
    buffer_load_dwordx4 v157, s[20:23], s50 offen offset:0 sc1 lds
    v_exp_f32 v57, v57
    v_exp_f32 v58, v58
    v_exp_f32 v59, v59
    v_exp_f32 v60, v60
    v_exp_f32 v61, v61
    v_smfmac_f32_32x32x32_bf16 v[84:99], v[28:31], v[52:59], v1
    ds_read_b128 v[140:143], v5 offset:55456
    ds_read_b128 v[28:31], v5 offset:54912
    v_exp_f32 v62, v62
    v_exp_f32 v63, v63
    v_exp_f32 v64, v64
    v_exp_f32 v65, v65
    v_exp_f32 v66, v66
    v_exp_f32 v67, v67
    v_exp_f32 v36, v36
    v_exp_f32 v37, v37
    v_smfmac_f32_32x32x32_bf16 v[84:99], v[32:35], v[60:67], v1
    s_waitcnt lgkmcnt(2)
    v_exp_f32 v38, v38
    v_exp_f32 v39, v39
    v_exp_f32 v40, v40
    v_mfma_f32_32x32x16_bf16 v[52:67], v[24:27], v[20:23], 0
    ds_read_b128 v[24:27], v2 offset:59136
    s_waitcnt lgkmcnt(1)
    v_exp_f32 v41, v41
    v_exp_f32 v42, v42
    v_exp_f32 v43, v43
    v_exp_f32 v44, v44
    v_exp_f32 v45, v45
    v_smfmac_f32_32x32x32_bf16 v[84:99], v[28:31], v[36:43], v1
    ds_read_b128 v[32:35], v5 offset:57568
    ds_read_b128 v[28:31], v5 offset:57024
    s_add_u32 m0, s63, 21504
    s_nop 0
    buffer_load_dwordx4 v157, s[20:23], s50 offen offset:2048 sc1 lds
    v_exp_f32 v46, v46
    v_exp_f32 v47, v47
    v_exp_f32 v48, v48
    v_exp_f32 v49, v49
    v_exp_f32 v50, v50
    v_exp_f32 v51, v51
    v_exp_f32 v52, v52
    v_exp_f32 v53, v53
    v_smfmac_f32_32x32x32_bf16 v[84:99], v[140:143], v[44:51], v1
    s_waitcnt lgkmcnt(2)
    s_add_u32 m0, s63, 24576
    s_nop 0
    buffer_load_dwordx4 v157, s[20:23], s51 offen offset:0 sc1 lds
    v_exp_f32 v54, v54
    v_exp_f32 v55, v55
    v_exp_f32 v56, v56
    v_mfma_f32_32x32x16_bf16 v[36:51], v[24:27], v[20:23], 0
    ds_read_b128 v[24:27], v2 offset:61248
    s_waitcnt lgkmcnt(1)
    v_exp_f32 v57, v57
    v_exp_f32 v58, v58
    v_exp_f32 v59, v59
    v_exp_f32 v60, v60
    v_exp_f32 v61, v61
    v_smfmac_f32_32x32x32_bf16 v[84:99], v[28:31], v[52:59], v1
    ds_read_b128 v[140:143], v5 offset:59680
    ds_read_b128 v[28:31], v5 offset:59136
    v_exp_f32 v62, v62
    v_exp_f32 v63, v63
    v_exp_f32 v64, v64
    v_exp_f32 v65, v65
    v_exp_f32 v66, v66
    v_exp_f32 v67, v67
    v_exp_f32 v36, v36
    v_exp_f32 v37, v37
    v_smfmac_f32_32x32x32_bf16 v[84:99], v[32:35], v[60:67], v1
    s_waitcnt lgkmcnt(2)
    v_exp_f32 v38, v38
    v_exp_f32 v39, v39
    v_exp_f32 v40, v40
    v_mfma_f32_32x32x16_bf16 v[52:67], v[24:27], v[20:23], 0
    ds_read_b128 v[24:27], v2 offset:63360
    s_waitcnt lgkmcnt(1)
    s_cmp_eq_u32 s85, 0
    s_cbranch_scc1 L_alt7
    s_waitcnt vmcnt(4)
    s_and_b64 exec, s[100:101], 1
    buffer_store_dword v10, off, s[20:23], s90 offset:0
    s_mov_b64 exec, -1
L_join8:
    v_exp_f32 v41, v41
    v_exp_f32 v42, v42
    v_exp_f32 v43, v43
    v_exp_f32 v44, v44
    v_exp_f32 v45, v45
    v_smfmac_f32_32x32x32_bf16 v[84:99], v[28:31], v[36:43], v1
    ds_read_b128 v[32:35], v5 offset:61792
    ds_read_b128 v[28:31], v5 offset:61248
    v_exp_f32 v46, v46
    v_exp_f32 v47, v47
    v_exp_f32 v48, v48
    v_exp_f32 v49, v49
    v_exp_f32 v50, v50
    v_exp_f32 v51, v51
    v_exp_f32 v52, v52
    v_exp_f32 v53, v53
    v_smfmac_f32_32x32x32_bf16 v[84:99], v[140:143], v[44:51], v1
    s_waitcnt lgkmcnt(2)
    v_exp_f32 v54, v54
    v_exp_f32 v55, v55
    v_exp_f32 v56, v56
    v_mfma_f32_32x32x16_bf16 v[36:51], v[24:27], v[20:23], 0
    ds_read_b128 v[24:27], v3 offset:0
    s_waitcnt lgkmcnt(1)
    v_exp_f32 v57, v57
    v_exp_f32 v58, v58
    v_exp_f32 v59, v59
    v_exp_f32 v60, v60
    v_exp_f32 v61, v61
    v_smfmac_f32_32x32x32_bf16 v[84:99], v[28:31], v[52:59], v1
    ds_read_b128 v[140:143], v5 offset:63904
    ds_read_b128 v[28:31], v5 offset:63360
    v_exp_f32 v62, v62
    v_exp_f32 v63, v63
    v_exp_f32 v64, v64
    v_exp_f32 v65, v65
    v_exp_f32 v66, v66
    v_exp_f32 v67, v67
    v_exp_f32 v36, v36
    v_exp_f32 v37, v37
    v_smfmac_f32_32x32x32_bf16 v[84:99], v[32:35], v[60:67], v1
    s_waitcnt lgkmcnt(2)
    v_exp_f32 v38, v38
    v_exp_f32 v39, v39
    v_exp_f32 v40, v40
    v_mfma_f32_32x32x16_bf16 v[52:67], v[24:27], v[20:23], 0
    s_waitcnt lgkmcnt(0)
    v_exp_f32 v41, v41
    v_exp_f32 v42, v42
    v_exp_f32 v43, v43
    v_exp_f32 v44, v44
    v_exp_f32 v45, v45
    v_smfmac_f32_32x32x32_bf16 v[84:99], v[28:31], v[36:43], v1
    ds_read_b128 v[32:35], v6 offset:544
    ds_read_b128 v[28:31], v6 offset:0
    buffer_load_dword v14, v159, s[20:23], 0 offen offset:0 sc1
    v_exp_f32 v46, v46
    v_exp_f32 v47, v47
    v_exp_f32 v48, v48
    v_exp_f32 v49, v49
    v_exp_f32 v50, v50
    v_exp_f32 v51, v51
    v_exp_f32 v52, v52
    v_exp_f32 v53, v53
    v_smfmac_f32_32x32x32_bf16 v[84:99], v[140:143], v[44:51], v1
    v_exp_f32 v54, v54
    v_exp_f32 v55, v55
    v_exp_f32 v56, v56
    s_waitcnt lgkmcnt(0)
    v_exp_f32 v57, v57
    v_exp_f32 v58, v58
    v_exp_f32 v59, v59
    v_exp_f32 v60, v60
    v_exp_f32 v61, v61
    v_smfmac_f32_32x32x32_bf16 v[84:99], v[28:31], v[52:59], v1
    v_exp_f32 v62, v62
    v_exp_f32 v63, v63
    v_exp_f32 v64, v64
    v_exp_f32 v65, v65
    v_exp_f32 v66, v66
    v_exp_f32 v67, v67
    s_waitcnt vmcnt(0)
    v_cmp_eq_u32 vcc, s39, v14
    s_lshl_b32 s88, s36, 14
    s_and_b64 vcc, vcc, s[100:101]
    s_cmp_eq_u64 vcc, -1
    s_cselect_b32 s89, s88, 0x40000000
    v_add_u32 v15, s89, v8
    buffer_load_dwordx4 v[116:119], v15, s[32:35], s72 offen offset:0 sc1
    buffer_load_dwordx4 v[120:123], v15, s[32:35], s72 offen offset:2048 sc1
    buffer_load_dwordx4 v[124:127], v15, s[32:35], s73 offen offset:0 sc1
    buffer_load_dwordx4 v[128:131], v15, s[32:35], s73 offen offset:2048 sc1
    buffer_load_dwordx4 v[132:135], v15, s[32:35], s74 offen offset:0 sc1
    buffer_load_dwordx4 v[136:139], v15, s[32:35], s74 offen offset:2048 sc1
    buffer_load_dwordx4 v[140:143], v15, s[32:35], s75 offen offset:0 sc1
    buffer_load_dwordx4 v[72:75], v15, s[32:35], s75 offen offset:2048 sc1
    v_smfmac_f32_32x32x32_bf16 v[84:99], v[32:35], v[60:67], v1
    s_nop 11
    v_pk_mul_f32 v[10:11], v[84:85], 0
    v_pk_fma_f32 v[10:11], v[86:87], 0, v[10:11]
    v_pk_fma_f32 v[10:11], v[88:89], 0, v[10:11]
    v_pk_fma_f32 v[10:11], v[90:91], 0, v[10:11]
    v_add_f32 v10, v10, v11
    v_add_f32 v11, v10, v92
    v_cmp_le_f32 vcc, s94, v11
    v_cmp_ge_f32 s[86:87], s95, v11
    s_and_b64 vcc, vcc, s[86:87]
    s_and_b64 vcc, vcc, s[100:101]
    s_cmp_eq_u64 vcc, -1
    s_cbranch_scc0 L_fb
L_fbdone:
    v_rcp_f32 v10, v92
    s_nop 0
    v_pk_mul_f32 v[84:85], v[84:85], v[10:11] op_sel_hi:[1,0]
    v_pk_mul_f32 v[86:87], v[86:87], v[10:11] op_sel_hi:[1,0]
    v_pk_mul_f32 v[88:89], v[88:89], v[10:11] op_sel_hi:[1,0]
    v_pk_mul_f32 v[90:91], v[90:91], v[10:11] op_sel_hi:[1,0]
    v_cvt_pk_bf16_f32 v48, v84, v85
    v_cvt_pk_bf16_f32 v49, v86, v87
    v_cvt_pk_bf16_f32 v50, v88, v89
    v_cvt_pk_bf16_f32 v51, v90, v91
    v_mov_b32 v10, s39
    s_cmp_eq_u32 s85, 0
    s_cbranch_scc1 L_alt10
    buffer_store_dwordx4 v[48:51], v8, s[32:35], s93 offen offset:1024
L_join11:
    v_add_u32 v11, s88, v8
    s_cmp_eq_u32 s88, s89
    s_cbranch_scc0 L_oslow
L_ook:
    v_pk_add_f32 v[100:101], v[100:101], v[102:103]
    v_pk_add_f32 v[108:109], v[108:109], v[110:111]
    v_pk_add_f32 v[104:105], v[104:105], v[106:107]
    v_pk_add_f32 v[112:113], v[112:113], v[114:115]
    v_pk_add_f32 v[100:101], v[100:101], v[104:105]
    v_pk_add_f32 v[108:109], v[108:109], v[112:113]
    v_add_f32 v100, v100, v101
    v_add_f32 v108, v108, v109
    v_mov_b32 v101, v100
    v_mov_b32 v109, v108
    s_nop 0
    v_permlane32_swap_b32 v100, v101
    v_permlane32_swap_b32 v108, v109
    v_add_f32 v100, v100, v101
    v_add_f32 v108, v108, v109
    v_and_b32 v101, 0xffff0000, v100
    v_and_b32 v109, 0xffff0000, v108
    v_sub_f32 v100, v100, v101
    v_sub_f32 v108, v108, v109
    v_cvt_pk_bf16_f32 v152, v101, v100
    v_cvt_pk_bf16_f32 v153, v109, v108
    s_waitcnt vmcnt(8)
    v_mfma_f32_32x32x16_bf16 v[80:95], v[160:163], v[116:119], 0
    v_lshlrev_b32 v40, 16, v144
    v_mfma_f32_32x32x16_bf16 v[96:111], v[164:167], v[116:119], 0
    v_and_b32 v44, 0xffff0000, v144
    s_waitcnt vmcnt(7)
    v_mfma_f32_32x32x16_bf16 v[80:95], v[168:171], v[120:123], v[80:95]
    v_lshlrev_b32 v41, 16, v145
    v_mfma_f32_32x32x16_bf16 v[96:111], v[172:175], v[120:123], v[96:111]
    v_and_b32 v45, 0xffff0000, v145
    s_waitcnt vmcnt(6)
    v_mfma_f32_32x32x16_bf16 v[80:95], v[176:179], v[124:127], v[80:95]
    v_lshlrev_b32 v42, 16, v146
    v_mfma_f32_32x32x16_bf16 v[96:111], v[180:183], v[124:127], v[96:111]
    v_and_b32 v46, 0xffff0000, v146
    s_waitcnt vmcnt(5)
    v_mfma_f32_32x32x16_bf16 v[80:95], v[184:187], v[128:131], v[80:95]
    v_lshlrev_b32 v43, 16, v147
    v_mfma_f32_32x32x16_bf16 v[96:111], v[188:191], v[128:131], v[96:111]
    v_and_b32 v47, 0xffff0000, v147
    s_waitcnt vmcnt(4)
    v_mfma_f32_32x32x16_bf16 v[80:95], v[192:195], v[132:135], v[80:95]
    s_xor_b32 s86, s36, 1
    s_mul_i32 s86, s86, 12288
    s_add_u32 s86, s86, 0
    v_add_u32 v2, s86, v8
    v_mfma_f32_32x32x16_bf16 v[96:111], v[196:199], v[132:135], v[96:111]
    s_xor_b32 s86, s36, 2
    s_mul_i32 s86, s86, 12288
    s_add_u32 s86, s86, 4096
    v_add_u32 v3, s86, v8
    s_cmp_eq_u32 s85, 0
    s_cbranch_scc1 L_alt20
    s_waitcnt vmcnt(0)
    s_mov_b64 exec, 1
    buffer_store_dword v10, off, s[20:23], s90 offset:128
    s_mov_b64 exec, -1
L_join21:
    v_mfma_f32_32x32x16_bf16 v[80:95], v[200:203], v[136:139], v[80:95]
    s_xor_b32 s86, s36, 3
    s_mul_i32 s86, s86, 12288
    s_add_u32 s86, s86, 8192
    v_add_u32 v4, s86, v8
    v_mfma_f32_32x32x16_bf16 v[96:111], v[204:207], v[136:139], v[96:111]
    s_mul_i32 s86, s36, 12288
    v_add_u32 v5, s86, v8
    s_barrier
    v_mfma_f32_32x32x16_bf16 v[80:95], v[208:211], v[140:143], v[80:95]
    s_lshl_b32 s86, s37, 11
    s_lshr_b32 s87, s36, 1
    s_lshl_b32 s87, s87, 10
    s_add_u32 s86, s86, s87
    v_mfma_f32_32x32x16_bf16 v[96:111], v[212:215], v[140:143], v[96:111]
    s_and_b32 s87, s36, 1
    s_lshl_b32 s87, s87, 3
    s_add_u32 s86, s86, s87
    s_add_u32 s86, s86, 180224
    v_add_u32 v12, s86, v8
    v_mfma_f32_32x32x16_bf16 v[80:95], v[216:219], v[72:75], v[80:95]
    v_mov_b32 v7, s97
    v_mfma_f32_32x32x16_bf16 v[96:111], v[220:223], v[72:75], v[96:111]
    s_nop 9
    ds_write_b128 v2, v[84:87] offset:0
    ds_write_b128 v3, v[88:91] offset:0
    ds_write_b128 v4, v[92:95] offset:0
    buffer_load_dword v14, v159, s[20:23], 0 offen offset:128 sc1
    ds_write_b128 v2, v[100:103] offset:2048
    ds_write_b128 v3, v[104:107] offset:2048
    ds_write_b128 v4, v[108:111] offset:2048
    v_pk_add_f32 v[80:81], v[80:81], v[40:41]
    v_pk_add_f32 v[82:83], v[82:83], v[42:43]
    v_pk_add_f32 v[96:97], v[96:97], v[44:45]
    v_pk_add_f32 v[98:99], v[98:99], v[46:47]
    s_waitcnt lgkmcnt(0)
    s_barrier
    ds_read_b128 v[16:19], v5 offset:0
    ds_read_b128 v[20:23], v5 offset:2048
    ds_read_b128 v[24:27], v5 offset:4096
    ds_read_b128 v[28:31], v5 offset:6144
    ds_read_b128 v[32:35], v5 offset:8192
    ds_read_b128 v[36:39], v5 offset:10240
    s_waitcnt vmcnt(0)
    v_cmp_ne_u32 vcc, s39, v14
    s_nop 0
    s_cmp_eq_u64 vcc, 0
    s_cbranch_scc0 L_xslow1
L_xok1:
    buffer_load_dwordx4 v[48:51], v11, s[32:35], s72 offen offset:1024 sc1
    s_waitcnt lgkmcnt(5)
    v_pk_add_f32 v[80:81], v[80:81], v[16:17]
    v_pk_add_f32 v[82:83], v[82:83], v[18:19]
    s_waitcnt lgkmcnt(4)
    v_pk_add_f32 v[96:97], v[96:97], v[20:21]
    buffer_load_dwordx4 v[52:55], v11, s[32:35], s72 offen offset:3072 sc1
    v_pk_add_f32 v[98:99], v[98:99], v[22:23]
    s_waitcnt lgkmcnt(3)
    v_pk_add_f32 v[80:81], v[80:81], v[24:25]
    v_pk_add_f32 v[82:83], v[82:83], v[26:27]
    buffer_load_dwordx4 v[56:59], v11, s[32:35], s73 offen offset:1024 sc1
    s_waitcnt lgkmcnt(2)
    v_pk_add_f32 v[96:97], v[96:97], v[28:29]
    v_pk_add_f32 v[98:99], v[98:99], v[30:31]
    s_waitcnt lgkmcnt(1)
    v_pk_add_f32 v[80:81], v[80:81], v[32:33]
    buffer_load_dwordx4 v[60:63], v11, s[32:35], s73 offen offset:3072 sc1
    v_pk_add_f32 v[82:83], v[82:83], v[34:35]
    s_waitcnt lgkmcnt(0)
    v_pk_add_f32 v[96:97], v[96:97], v[36:37]
    v_pk_add_f32 v[98:99], v[98:99], v[38:39]
    buffer_load_dwordx4 v[64:67], v11, s[32:35], s74 offen offset:1024 sc1
    v_cvt_pk_bf16_f32 v144, v80, v96
    v_cvt_pk_bf16_f32 v145, v81, v97
    v_cvt_pk_bf16_f32 v146, v82, v98
    buffer_load_dwordx4 v[68:71], v11, s[32:35], s74 offen offset:3072 sc1
    v_cvt_pk_bf16_f32 v147, v83, v99
    s_cmp_eq_u32 s85, 0
    s_cbranch_scc1 L_alt24
    buffer_store_dwordx4 v[144:147], v8, s[32:35], s91 offen
L_join25:
    buffer_load_dwordx4 v[72:75], v11, s[32:35], s75 offen offset:1024 sc1
    buffer_load_dwordx4 v[76:79], v11, s[32:35], s75 offen offset:3072 sc1
    s_waitcnt vmcnt(8)
    v_mfma_f32_32x32x16_bf16 v[112:127], v[160:163], v[48:51], 0
    v_lshlrev_b32 v40, 16, v148
    v_mfma_f32_32x32x16_bf16 v[128:143], v[164:167], v[48:51], 0
    v_and_b32 v44, 0xffff0000, v148
    s_waitcnt vmcnt(7)
    v_mfma_f32_32x32x16_bf16 v[112:127], v[168:171], v[52:55], v[112:127]
    v_lshlrev_b32 v41, 16, v149
    v_mfma_f32_32x32x16_bf16 v[128:143], v[172:175], v[52:55], v[128:143]
    v_and_b32 v45, 0xffff0000, v149
    s_waitcnt vmcnt(6)
    v_mfma_f32_32x32x16_bf16 v[112:127], v[176:179], v[56:59], v[112:127]
    v_lshlrev_b32 v42, 16, v150
    v_mfma_f32_32x32x16_bf16 v[128:143], v[180:183], v[56:59], v[128:143]
    v_and_b32 v46, 0xffff0000, v150
    s_waitcnt vmcnt(5)
    v_mfma_f32_32x32x16_bf16 v[112:127], v[184:187], v[60:63], v[112:127]
    v_lshlrev_b32 v43, 16, v151
    v_mfma_f32_32x32x16_bf16 v[128:143], v[188:191], v[60:63], v[128:143]
    v_and_b32 v47, 0xffff0000, v151
    s_waitcnt vmcnt(4)
    v_mfma_f32_32x32x16_bf16 v[112:127], v[192:195], v[64:67], v[112:127]
    buffer_load_dwordx4 v[160:163], v157, s[20:23], s44 offen offset:1024 sc1
    v_mfma_f32_32x32x16_bf16 v[128:143], v[196:199], v[64:67], v[128:143]
    buffer_load_dwordx4 v[164:167], v157, s[20:23], s44 offen offset:3072 sc1
    s_waitcnt vmcnt(5)
    v_mfma_f32_32x32x16_bf16 v[112:127], v[200:203], v[68:71], v[112:127]
    buffer_load_dwordx4 v[168:171], v157, s[20:23], s45 offen offset:1024 sc1
    v_mfma_f32_32x32x16_bf16 v[128:143], v[204:207], v[68:71], v[128:143]
    buffer_load_dwordx4 v[172:175], v157, s[20:23], s45 offen offset:3072 sc1
    s_cmp_eq_u32 s85, 0
    s_cbranch_scc1 L_alt26
    s_waitcnt vmcnt(6)
    s_mov_b64 exec, 1
    buffer_store_dword v10, off, s[20:23], s90 offset:256
    s_mov_b64 exec, -1
L_join27:
    s_waitcnt vmcnt(6)
    v_mfma_f32_32x32x16_bf16 v[112:127], v[208:211], v[72:75], v[112:127]
    buffer_load_dwordx4 v[176:179], v157, s[20:23], s46 offen offset:1024 sc1
    v_mfma_f32_32x32x16_bf16 v[128:143], v[212:215], v[72:75], v[128:143]
    buffer_load_dwordx4 v[180:183], v157, s[20:23], s46 offen offset:3072 sc1
    s_waitcnt vmcnt(7)
    v_mfma_f32_32x32x16_bf16 v[112:127], v[216:219], v[76:79], v[112:127]
    buffer_load_dwordx4 v[184:187], v157, s[20:23], s47 offen offset:1024 sc1
    v_mfma_f32_32x32x16_bf16 v[128:143], v[220:223], v[76:79], v[128:143]
    buffer_load_dwordx4 v[188:191], v157, s[20:23], s47 offen offset:3072 sc1
    v_dot2_f32_bf16 v72, v144, v7, 0
    v_dot2_f32_bf16 v74, v144, v144, 0
    v_dot2_f32_bf16 v72, v145, v7, v72
    v_dot2_f32_bf16 v74, v145, v145, v74
    s_nop 4
    ds_write_b128 v2, v[116:119] offset:1024
    v_dot2_f32_bf16 v72, v146, v7, v72
    ds_write_b128 v3, v[120:123] offset:1024
    v_dot2_f32_bf16 v74, v146, v146, v74
    buffer_load_dword v14, v159, s[20:23], 0 offen offset:256 sc1
    ds_write_b128 v4, v[124:127] offset:1024
    v_dot2_f32_bf16 v72, v147, v7, v72
    ds_write_b128 v2, v[132:135] offset:3072
    v_dot2_f32_bf16 v74, v147, v147, v74
    ds_write_b128 v3, v[136:139] offset:3072
    ds_write_b128 v4, v[140:143] offset:3072
    v_pk_add_f32 v[112:113], v[112:113], v[40:41]
    v_pk_add_f32 v[114:115], v[114:115], v[42:43]
    v_pk_add_f32 v[128:129], v[128:129], v[44:45]
    v_pk_add_f32 v[130:131], v[130:131], v[46:47]
    s_mul_i32 s86, s37, 7
    s_lshl_b32 s87, s36, 1
    s_add_u32 s86, s86, s87
    s_lshl_b32 s86, s86, 11
    v_add_u32 v6, s86, v8
    s_add_u32 s94, s86, 2048
    s_cmp_eq_u32 s36, 3
    s_cselect_b32 s95, 0x40000000, s94
    s_mul_i32 s86, s36, 28672
    s_mov_b32 s93, 114688
    v_add_u32 v11, s86, v8
    s_add_u32 s86, s63, 2048
    v_add_u32 v15, s86, v8
    s_lshl_b32 s89, s36, 12
    s_add_u32 s89, s89, 180224
    s_lshl_b32 s88, s36, 14
    s_add_u32 s88, s88, 114688
    s_sub_u32 s86, s36, s78
    s_and_b32 s86, s86, 3
    s_lshl_b32 m0, s86, 14
    s_mov_b32 s94, 0x3b000000
    s_waitcnt lgkmcnt(0)
    s_barrier
    ds_read_b128 v[48:51], v5 offset:1024
    ds_read_b128 v[52:55], v5 offset:3072
    ds_read_b128 v[56:59], v5 offset:5120
    ds_read_b128 v[60:63], v5 offset:7168
    ds_read_b128 v[64:67], v5 offset:9216
    ds_read_b128 v[68:71], v5 offset:11264
    s_waitcnt lgkmcnt(5)
    v_pk_add_f32 v[112:113], v[112:113], v[48:49]
    v_pk_add_f32 v[114:115], v[114:115], v[50:51]
    s_waitcnt lgkmcnt(4)
    v_pk_add_f32 v[128:129], v[128:129], v[52:53]
    v_pk_add_f32 v[130:131], v[130:131], v[54:55]
    s_waitcnt lgkmcnt(3)
    v_pk_add_f32 v[112:113], v[112:113], v[56:57]
    v_pk_add_f32 v[114:115], v[114:115], v[58:59]
    s_waitcnt lgkmcnt(2)
    v_pk_add_f32 v[128:129], v[128:129], v[60:61]
    v_pk_add_f32 v[130:131], v[130:131], v[62:63]
    s_waitcnt lgkmcnt(1)
    v_pk_add_f32 v[112:113], v[112:113], v[64:65]
    v_pk_add_f32 v[114:115], v[114:115], v[66:67]
    s_waitcnt lgkmcnt(0)
    v_pk_add_f32 v[128:129], v[128:129], v[68:69]
    v_pk_add_f32 v[130:131], v[130:131], v[70:71]
    v_cvt_pk_bf16_f32 v148, v112, v128
    v_cvt_pk_bf16_f32 v149, v113, v129
    v_cvt_pk_bf16_f32 v150, v114, v130
    v_cvt_pk_bf16_f32 v151, v115, v131
    s_cmp_eq_u32 s85, 0
    s_cbranch_scc1 L_alt28
    buffer_store_dwordx4 v[148:151], v8, s[32:35], s91 offen offset:1024
L_join29:
    s_waitcnt vmcnt(1)
    v_cmp_ne_u32 vcc, s39, v14
    s_nop 0
    s_cmp_eq_u64 vcc, 0
    s_cbranch_scc0 L_xslow2
L_xok2:
    buffer_load_dwordx4 v8, s[32:35], s88 offen offset:0 sc1 lds
    v_dot2_f32_bf16 v73, v148, v7, 0
    v_dot2_f32_bf16 v75, v148, v148, 0
    v_dot2_f32_bf16 v73, v149, v7, v73
    v_dot2_f32_bf16 v75, v149, v149, v75
    v_dot2_f32_bf16 v73, v150, v7, v73
    v_dot2_f32_bf16 v75, v150, v150, v75
    buffer_load_dwordx4 v8, s[32:35], s88 offen offset:2048 sc1 lds
    v_dot2_f32_bf16 v73, v151, v7, v73
    v_dot2_f32_bf16 v75, v151, v151, v75
    s_nop 1
    v_permlane32_swap_b32 v72, v73
    v_permlane32_swap_b32 v74, v75
    v_add_f32 v72, v72, v73
    v_add_f32 v73, v74, v75
    s_add_u32 m0, m0, 4096
    s_add_u32 s88, s88, 4096
    buffer_load_dwordx4 v8, s[32:35], s88 offen offset:0 sc1 lds
    s_cmp_eq_u32 s85, 0
    s_cbranch_scc1 L_alt32
    buffer_store_dwordx2 v[72:73], v12, s[32:35], 0 offen
L_join33:
    v_add_u32 v7, s95, v8
    v_lshlrev_b32 v12, 3, v0
    v_add_u32 v12, 161792, v12
    s_lshl_b32 s86, s36, 9
    v_add_u32 v9, s86, v12
    v_mov_b32 v48, v152
    buffer_load_dwordx4 v8, s[32:35], s88 offen offset:2048 sc1 lds
    v_mov_b32 v52, v153
    v_mov_b32 v49, 0
    v_pk_mul_f32 v[50:51], 0, 0
    v_mov_b32 v53, 0
    v_pk_mul_f32 v[54:55], 0, 0
    v_mov_b32 v57, 0
    s_add_u32 m0, m0, 4096
    s_add_u32 s88, s88, 4096
    buffer_load_dwordx4 v8, s[32:35], s88 offen offset:0 sc1 lds
    v_pk_mul_f32 v[58:59], 0, 0
    v_mov_b32 v61, 0
    v_pk_mul_f32 v[62:63], 0, 0
    buffer_load_dwordx4 v8, s[32:35], s88 offen offset:2048 sc1 lds
    s_add_u32 m0, m0, 4096
    s_add_u32 s88, s88, 4096
    buffer_load_dwordx4 v8, s[32:35], s88 offen offset:0 sc1 lds
    buffer_load_dwordx4 v8, s[32:35], s88 offen offset:2048 sc1 lds
    s_cmp_eq_u32 s85, 0
    s_cbranch_scc1 L_alt34
    s_waitcnt vmcnt(5)
    s_mov_b64 exec, 1
    buffer_store_dword v10, off, s[20:23], s90 offset:384
    s_mov_b64 exec, -1
L_join35:
    s_waitcnt vmcnt(1)
    s_barrier
    ds_read_b128 v[16:19], v8 offset:0
    ds_read_b128 v[20:23], v8 offset:2048
    ds_read_b128 v[24:27], v8 offset:4096
    ds_read_b128 v[28:31], v8 offset:6144
    ds_read_b128 v[32:35], v8 offset:8192
    ds_read_b128 v[36:39], v8 offset:10240
    s_waitcnt lgkmcnt(5)
    v_mfma_f32_32x32x16_bf16 v[80:95], a[0:3], v[16:19], 0
    ds_read_b128 v[40:43], v8 offset:12288
    v_mfma_f32_32x32x16_bf16 v[96:111], a[4:7], v[16:19], 0
    s_waitcnt lgkmcnt(5)
    v_mfma_f32_32x32x16_bf16 v[80:95], a[8:11], v[20:23], v[80:95]
    ds_read_b128 v[44:47], v8 offset:14336
    v_mfma_f32_32x32x16_bf16 v[96:111], a[12:15], v[20:23], v[96:111]
    s_waitcnt lgkmcnt(5)
    v_mfma_f32_32x32x16_bf16 v[80:95], a[16:19], v[24:27], v[80:95]
    ds_read_b128 v[16:19], v8 offset:16384
    v_mfma_f32_32x32x16_bf16 v[96:111], a[20:23], v[24:27], v[96:111]
    s_waitcnt lgkmcnt(5)
    v_mfma_f32_32x32x16_bf16 v[80:95], a[24:27], v[28:31], v[80:95]
    ds_read_b128 v[20:23], v8 offset:18432
    v_mfma_f32_32x32x16_bf16 v[96:111], a[28:31], v[28:31], v[96:111]
    buffer_load_dword v14, v159, s[20:23], 0 offen offset:384 sc1
    s_waitcnt lgkmcnt(5)
    v_mfma_f32_32x32x16_bf16 v[80:95], a[32:35], v[32:35], v[80:95]
    ds_read_b128 v[24:27], v8 offset:20480
    v_mfma_f32_32x32x16_bf16 v[96:111], a[36:39], v[32:35], v[96:111]
    s_waitcnt lgkmcnt(5)
    v_mfma_f32_32x32x16_bf16 v[80:95], a[40:43], v[36:39], v[80:95]
    ds_read_b128 v[28:31], v8 offset:22528
    v_mfma_f32_32x32x16_bf16 v[96:111], a[44:47], v[36:39], v[96:111]
    s_waitcnt lgkmcnt(5)
    v_mfma_f32_32x32x16_bf16 v[80:95], a[48:51], v[40:43], v[80:95]
    ds_read_b128 v[32:35], v8 offset:24576
    v_mfma_f32_32x32x16_bf16 v[96:111], a[52:55], v[40:43], v[96:111]
    s_waitcnt lgkmcnt(5)
    v_mfma_f32_32x32x16_bf16 v[80:95], a[56:59], v[44:47], v[80:95]
    ds_read_b128 v[36:39], v8 offset:26624
    v_mfma_f32_32x32x16_bf16 v[96:111], a[60:63], v[44:47], v[96:111]
    s_waitcnt lgkmcnt(5)
    v_mfma_f32_32x32x16_bf16 v[80:95], a[64:67], v[16:19], v[80:95]
    ds_read_b128 v[40:43], v8 offset:28672
    s_waitcnt vmcnt(0)
    v_cmp_ne_u32 vcc, s39, v14
    s_nop 0
    s_cmp_eq_u64 vcc, 0
    s_cbranch_scc0 L_xslow3
L_xok3:
    buffer_load_dwordx4 v[64:67], v8, s[32:35], s89 offen offset:0 sc1
    v_mfma_f32_32x32x16_bf16 v[96:111], a[68:71], v[16:19], v[96:111]
    s_waitcnt lgkmcnt(5)
    v_mfma_f32_32x32x16_bf16 v[80:95], a[72:75], v[20:23], v[80:95]
    ds_read_b128 v[44:47], v8 offset:30720
    buffer_load_dwordx4 v[68:71], v8, s[32:35], s89 offen offset:1024 sc1
    v_mfma_f32_32x32x16_bf16 v[96:111], a[76:79], v[20:23], v[96:111]
    s_waitcnt lgkmcnt(5)
    v_mfma_f32_32x32x16_bf16 v[80:95], a[80:83], v[24:27], v[80:95]
    ds_read_b128 v[16:19], v8 offset:32768
    buffer_load_dwordx4 v[72:75], v8, s[32:35], s89 offen offset:2048 sc1
    v_mfma_f32_32x32x16_bf16 v[96:111], a[84:87], v[24:27], v[96:111]
    s_waitcnt lgkmcnt(5)
    v_mfma_f32_32x32x16_bf16 v[80:95], a[88:91], v[28:31], v[80:95]
    ds_read_b128 v[20:23], v8 offset:34816
    buffer_load_dwordx4 v[76:79], v8, s[32:35], s89 offen offset:3072 sc1
    v_mfma_f32_32x32x16_bf16 v[96:111], a[92:95], v[28:31], v[96:111]
    s_waitcnt lgkmcnt(5)
    v_mfma_f32_32x32x16_bf16 v[80:95], a[96:99], v[32:35], v[80:95]
    ds_read_b128 v[24:27], v8 offset:36864
    s_sub_u32 m0, m0, 12288
    s_sub_u32 s88, s88, 12288
    buffer_load_dwordx4 v8, s[32:35], s88 offen offset:1024 sc1 lds
    v_mfma_f32_32x32x16_bf16 v[96:111], a[100:103], v[32:35], v[96:111]
    s_waitcnt lgkmcnt(5)
    v_mfma_f32_32x32x16_bf16 v[80:95], a[104:107], v[36:39], v[80:95]
    ds_read_b128 v[28:31], v8 offset:38912
    buffer_load_dwordx4 v8, s[32:35], s88 offen offset:3072 sc1 lds
    v_mfma_f32_32x32x16_bf16 v[96:111], a[108:111], v[36:39], v[96:111]
    s_waitcnt lgkmcnt(5)
    v_mfma_f32_32x32x16_bf16 v[80:95], a[112:115], v[40:43], v[80:95]
    ds_read_b128 v[32:35], v8 offset:40960
    s_add_u32 m0, m0, 4096
    s_add_u32 s88, s88, 4096
    buffer_load_dwordx4 v8, s[32:35], s88 offen offset:1024 sc1 lds
    v_mfma_f32_32x32x16_bf16 v[96:111], a[116:119], v[40:43], v[96:111]
    s_waitcnt lgkmcnt(5)
    v_mfma_f32_32x32x16_bf16 v[80:95], a[120:123], v[44:47], v[80:95]
    ds_read_b128 v[36:39], v8 offset:43008
    buffer_load_dwordx4 v8, s[32:35], s88 offen offset:3072 sc1 lds
    v_mfma_f32_32x32x16_bf16 v[96:111], a[124:127], v[44:47], v[96:111]
    s_waitcnt lgkmcnt(5)
    v_mfma_f32_32x32x16_bf16 v[80:95], a[128:131], v[16:19], v[80:95]
    ds_read_b128 v[40:43], v8 offset:45056
    s_add_u32 m0, m0, 4096
    s_add_u32 s88, s88, 4096
    buffer_load_dwordx4 v8, s[32:35], s88 offen offset:1024 sc1 lds
    s_waitcnt vmcnt(5)
    v_pk_add_f32 v[64:65], v[64:65], v[66:67]
    v_mfma_f32_32x32x16_bf16 v[96:111], a[132:135], v[16:19], v[96:111]
    v_pk_add_f32 v[68:69], v[68:69], v[70:71]
    s_waitcnt lgkmcnt(5)
    v_mfma_f32_32x32x16_bf16 v[80:95], a[136:139], v[20:23], v[80:95]
    ds_read_b128 v[44:47], v8 offset:47104
    buffer_load_dwordx4 v8, s[32:35], s88 offen offset:3072 sc1 lds
    v_pk_add_f32 v[72:73], v[72:73], v[74:75]
    v_mfma_f32_32x32x16_bf16 v[96:111], a[140:143], v[20:23], v[96:111]
    v_pk_add_f32 v[76:77], v[76:77], v[78:79]
    s_waitcnt lgkmcnt(5)
    v_mfma_f32_32x32x16_bf16 v[80:95], a[144:147], v[24:27], v[80:95]
    ds_read_b128 v[16:19], v8 offset:49152
    s_add_u32 m0, m0, 4096
    s_add_u32 s88, s88, 4096
    buffer_load_dwordx4 v8, s[32:35], s88 offen offset:1024 sc1 lds
    v_pk_add_f32 v[64:65], v[64:65], v[68:69]
    v_mfma_f32_32x32x16_bf16 v[96:111], a[148:151], v[24:27], v[96:111]
    v_pk_add_f32 v[72:73], v[72:73], v[76:77]
    s_waitcnt lgkmcnt(5)
    v_mfma_f32_32x32x16_bf16 v[80:95], a[152:155], v[28:31], v[80:95]
    ds_read_b128 v[20:23], v8 offset:51200
    buffer_load_dwordx4 v8, s[32:35], s88 offen offset:3072 sc1 lds
    v_pk_add_f32 v[64:65], v[64:65], v[72:73]
    ds_write_b64 v9, v[64:65]
    v_mfma_f32_32x32x16_bf16 v[96:111], a[156:159], v[28:31], v[96:111]
    buffer_load_dwordx4 v[192:195], v157, s[20:23], s48 offen offset:1024 sc1
    s_waitcnt lgkmcnt(6)
    v_mfma_f32_32x32x16_bf16 v[80:95], a[160:163], v[32:35], v[80:95]
    ds_read_b128 v[24:27], v8 offset:53248
    v_mfma_f32_32x32x16_bf16 v[96:111], a[164:167], v[32:35], v[96:111]
    buffer_load_dwordx4 v[196:199], v157, s[20:23], s48 offen offset:3072 sc1
    s_waitcnt lgkmcnt(6)
    v_mfma_f32_32x32x16_bf16 v[80:95], a[168:171], v[36:39], v[80:95]
    ds_read_b128 v[28:31], v8 offset:55296
    v_mfma_f32_32x32x16_bf16 v[96:111], a[172:175], v[36:39], v[96:111]
    buffer_load_dwordx4 v[200:203], v157, s[20:23], s49 offen offset:1024 sc1
    s_waitcnt lgkmcnt(2)
    s_barrier
    ds_read2st64_b64 v[64:67], v12 offset1:1
    ds_read2st64_b64 v[68:71], v12 offset0:2 offset1:3
    v_mfma_f32_32x32x16_bf16 v[80:95], a[176:179], v[40:43], v[80:95]
    ds_read_b128 v[32:35], v8 offset:57344
    v_mfma_f32_32x32x16_bf16 v[96:111], a[180:183], v[40:43], v[96:111]
    buffer_load_dwordx4 v[204:207], v157, s[20:23], s49 offen offset:3072 sc1
    v_mfma_f32_32x32x16_bf16 v[80:95], a[184:187], v[44:47], v[80:95]
    ds_read_b128 v[36:39], v8 offset:59392
    s_waitcnt lgkmcnt(2)
    v_add_f32 v64, v64, v66
    v_add_f32 v65, v65, v67
    v_mfma_f32_32x32x16_bf16 v[96:111], a[188:191], v[44:47], v[96:111]
    buffer_load_dwordx4 v[208:211], v157, s[20:23], s50 offen offset:1024 sc1
    v_add_f32 v68, v68, v70
    v_add_f32 v69, v69, v71
    v_mfma_f32_32x32x16_bf16 v[80:95], a[192:195], v[16:19], v[80:95]
    ds_read_b128 v[40:43], v8 offset:61440
    v_add_f32 v64, v64, v68
    v_mfma_f32_32x32x16_bf16 v[96:111], a[196:199], v[16:19], v[96:111]
    buffer_load_dwordx4 v[212:215], v157, s[20:23], s50 offen offset:3072 sc1
    v_add_f32 v65, v65, v69
    v_mfma_f32_32x32x16_bf16 v[80:95], a[200:203], v[20:23], v[80:95]
    ds_read_b128 v[44:47], v8 offset:63488
    v_mul_f32 v64, 0xbb000000, v64
    v_mfma_f32_32x32x16_bf16 v[96:111], a[204:207], v[20:23], v[96:111]
    buffer_load_dwordx4 v[216:219], v157, s[20:23], s51 offen offset:1024 sc1
    s_waitcnt vmcnt(7)
    s_barrier
    v_mul_f32 v154, v64, v64
    v_mfma_f32_32x32x16_bf16 v[80:95], a[208:211], v[24:27], v[80:95]
    ds_read_b128 v[16:19], v8 offset:1024
    v_fma_f32 v154, v65, s94, -v154
    v_mfma_f32_32x32x16_bf16 v[96:111], a[212:215], v[24:27], v[96:111]
    buffer_load_dwordx4 v[220:223], v157, s[20:23], s51 offen offset:2048 sc1
    v_max_f32 v154, 0, v154
    v_mfma_f32_32x32x16_bf16 v[80:95], a[216:219], v[28:31], v[80:95]
    ds_read_b128 v[20:23], v8 offset:3072
    v_add_f32 v154, 0x3727c5ac, v154
    v_mfma_f32_32x32x16_bf16 v[96:111], a[220:223], v[28:31], v[96:111]
    v_rsq_f32 v154, v154
    s_waitcnt lgkmcnt(5)
    v_mfma_f32_32x32x16_bf16 v[80:95], a[224:227], v[32:35], v[80:95]
    ds_read_b128 v[24:27], v8 offset:5120
    v_and_b32 v66, 0xffff0000, v64
    v_mfma_f32_32x32x16_bf16 v[96:111], a[228:231], v[32:35], v[96:111]
    v_sub_f32 v67, v64, v66
    s_waitcnt lgkmcnt(5)
    v_mfma_f32_32x32x16_bf16 v[80:95], a[232:235], v[36:39], v[80:95]
    ds_read_b128 v[28:31], v8 offset:7168
    v_mov_b32 v1, v154
    v_mfma_f32_32x32x16_bf16 v[96:111], a[236:239], v[36:39], v[96:111]
    v_cvt_pk_bf16_f32 v56, v66, v66
    s_waitcnt lgkmcnt(5)
    v_mfma_f32_32x32x16_bf16 v[80:95], a[240:243], v[40:43], v[80:95]
    ds_read_b128 v[32:35], v8 offset:9216
    v_cvt_pk_bf16_f32 v60, v67, v67
    v_mfma_f32_32x32x16_bf16 v[96:111], a[244:247], v[40:43], v[96:111]
    v_permlane32_swap_b32 v154, v1
    s_waitcnt lgkmcnt(5)
    v_mfma_f32_32x32x16_bf16 v[80:95], a[248:251], v[44:47], v[80:95]
    ds_read_b128 v[36:39], v8 offset:11264
    v_permlane32_swap_b32 v56, v60
    v_mfma_f32_32x32x16_bf16 v[96:111], a[252:255], v[44:47], v[96:111]
    s_nop 0
    v_mfma_f32_32x32x16_bf16 v[80:95], v[48:51], v[56:59], v[80:95]
    v_mfma_f32_32x32x16_bf16 v[96:111], v[52:55], v[56:59], v[96:111]
    s_waitcnt lgkmcnt(5)
    v_mfma_f32_32x32x16_bf16 v[112:127], a[0:3], v[16:19], 0
    ds_read_b128 v[40:43], v8 offset:13312
    v_mfma_f32_32x32x16_bf16 v[128:143], a[4:7], v[16:19], 0
    s_waitcnt lgkmcnt(5)
    v_mfma_f32_32x32x16_bf16 v[112:127], a[8:11], v[20:23], v[112:127]
    ds_read_b128 v[44:47], v8 offset:15360
    buffer_load_dwordx4 a[0:3], v157, s[20:23], s51 offen offset:3072 sc1
    s_nop 2
    v_cvt_pk_bf16_f32 v64, v80, v81
    v_cvt_pk_bf16_f32 v65, v82, v83
    v_mfma_f32_32x32x16_bf16 v[128:143], a[12:15], v[20:23], v[128:143]
    buffer_load_dwordx4 a[4:7], v157, s[20:23], s52 offen offset:0 sc1
    v_cvt_pk_bf16_f32 v66, v84, v85
    v_cvt_pk_bf16_f32 v67, v86, v87
    s_waitcnt lgkmcnt(5)
    v_mfma_f32_32x32x16_bf16 v[112:127], a[16:19], v[24:27], v[112:127]
    ds_read_b128 v[16:19], v8 offset:17408
    buffer_load_dwordx4 a[8:11], v157, s[20:23], s52 offen offset:1024 sc1
    v_cvt_pk_bf16_f32 v68, v88, v89
    v_cvt_pk_bf16_f32 v69, v90, v91
    v_mfma_f32_32x32x16_bf16 v[128:143], a[20:23], v[24:27], v[128:143]
    buffer_load_dwordx4 a[12:15], v157, s[20:23], s52 offen offset:2048 sc1
    v_cvt_pk_bf16_f32 v70, v92, v93
    v_cvt_pk_bf16_f32 v71, v94, v95
    s_waitcnt lgkmcnt(5)
    v_mfma_f32_32x32x16_bf16 v[112:127], a[24:27], v[28:31], v[112:127]
    ds_read_b128 v[20:23], v8 offset:19456
    buffer_load_dwordx4 a[16:19], v157, s[20:23], s52 offen offset:3072 sc1
    v_pk_max_i16 v64, v64, 0
    v_pk_max_i16 v65, v65, 0
    v_mfma_f32_32x32x16_bf16 v[128:143], a[28:31], v[28:31], v[128:143]
    buffer_load_dwordx4 a[20:23], v157, s[20:23], s53 offen offset:0 sc1
    v_pk_max_i16 v66, v66, 0
    v_pk_max_i16 v67, v67, 0
    s_waitcnt lgkmcnt(5)
    v_mfma_f32_32x32x16_bf16 v[112:127], a[32:35], v[32:35], v[112:127]
    ds_read_b128 v[24:27], v8 offset:21504
    buffer_load_dwordx4 a[24:27], v157, s[20:23], s53 offen offset:1024 sc1
    v_pk_max_i16 v68, v68, 0
    v_pk_max_i16 v69, v69, 0
    v_mfma_f32_32x32x16_bf16 v[128:143], a[36:39], v[32:35], v[128:143]
    buffer_load_dwordx4 a[28:31], v157, s[20:23], s53 offen offset:2048 sc1
    v_pk_max_i16 v70, v70, 0
    v_pk_max_i16 v71, v71, 0
    s_waitcnt lgkmcnt(5)
    v_mfma_f32_32x32x16_bf16 v[112:127], a[40:43], v[36:39], v[112:127]
    ds_read_b128 v[28:31], v8 offset:23552
    buffer_load_dwordx4 a[32:35], v157, s[20:23], s53 offen offset:3072 sc1
    v_cvt_pk_bf16_f32 v72, v96, v97
    v_cvt_pk_bf16_f32 v73, v98, v99
    v_mfma_f32_32x32x16_bf16 v[128:143], a[44:47], v[36:39], v[128:143]
    v_cvt_pk_bf16_f32 v74, v100, v101
    v_cvt_pk_bf16_f32 v75, v102, v103
    s_waitcnt lgkmcnt(5)
    v_mfma_f32_32x32x16_bf16 v[112:127], a[48:51], v[40:43], v[112:127]
    ds_read_b128 v[32:35], v8 offset:25600
    v_cvt_pk_bf16_f32 v76, v104, v105
    v_cvt_pk_bf16_f32 v77, v106, v107
    v_mfma_f32_32x32x16_bf16 v[128:143], a[52:55], v[40:43], v[128:143]
    v_cvt_pk_bf16_f32 v78, v108, v109
    v_cvt_pk_bf16_f32 v79, v110, v111
    s_waitcnt lgkmcnt(5)
    v_mfma_f32_32x32x16_bf16 v[112:127], a[56:59], v[44:47], v[112:127]
    ds_read_b128 v[36:39], v8 offset:27648
    v_pk_max_i16 v72, v72, 0
    v_pk_max_i16 v73, v73, 0
    v_mfma_f32_32x32x16_bf16 v[128:143], a[60:63], v[44:47], v[128:143]
    v_pk_max_i16 v74, v74, 0
    v_pk_max_i16 v75, v75, 0
    s_waitcnt lgkmcnt(5)
    v_mfma_f32_32x32x16_bf16 v[112:127], a[64:67], v[16:19], v[112:127]
    ds_read_b128 v[40:43], v8 offset:29696
    v_pk_max_i16 v76, v76, 0
    v_pk_max_i16 v77, v77, 0
    v_mfma_f32_32x32x16_bf16 v[128:143], a[68:71], v[16:19], v[128:143]
    v_pk_max_i16 v78, v78, 0
    v_pk_max_i16 v79, v79, 0
    s_waitcnt lgkmcnt(5)
    v_mfma_f32_32x32x16_bf16 v[112:127], a[72:75], v[20:23], v[112:127]
    ds_read_b128 v[44:47], v8 offset:31744
    v_mfma_f32_32x32x16_bf16 v[128:143], a[76:79], v[20:23], v[128:143]
    s_cmp_eq_u32 s85, 0
    s_cbranch_scc1 L_alt38
    buffer_store_dwordx4 v[64:67], v6, s[32:35], 0 offen offset:0
    buffer_store_dwordx4 v[68:71], v6, s[32:35], 0 offen offset:1024
    buffer_store_dwordx4 v[72:75], v7, s[32:35], 0 offen offset:0
    buffer_store_dwordx4 v[76:79], v7, s[32:35], 0 offen offset:1024
L_join39:
    s_waitcnt lgkmcnt(5)
    v_mfma_f32_32x32x16_bf16 v[112:127], a[80:83], v[24:27], v[112:127]
    ds_read_b128 v[16:19], v8 offset:33792
    v_mfma_f32_32x32x16_bf16 v[128:143], a[84:87], v[24:27], v[128:143]
    s_waitcnt lgkmcnt(5)
    v_mfma_f32_32x32x16_bf16 v[112:127], a[88:91], v[28:31], v[112:127]
    ds_read_b128 v[20:23], v8 offset:35840
    v_mfma_f32_32x32x16_bf16 v[128:143], a[92:95], v[28:31], v[128:143]
    s_waitcnt lgkmcnt(5)
    v_mfma_f32_32x32x16_bf16 v[112:127], a[96:99], v[32:35], v[112:127]
    ds_read_b128 v[24:27], v8 offset:37888
    v_mfma_f32_32x32x16_bf16 v[128:143], a[100:103], v[32:35], v[128:143]
    s_waitcnt lgkmcnt(5)
    v_mfma_f32_32x32x16_bf16 v[112:127], a[104:107], v[36:39], v[112:127]
    ds_read_b128 v[28:31], v8 offset:39936
    v_mfma_f32_32x32x16_bf16 v[128:143], a[108:111], v[36:39], v[128:143]
    s_waitcnt lgkmcnt(5)
    v_mfma_f32_32x32x16_bf16 v[112:127], a[112:115], v[40:43], v[112:127]
    ds_read_b128 v[32:35], v8 offset:41984
    v_mfma_f32_32x32x16_bf16 v[128:143], a[116:119], v[40:43], v[128:143]
    s_waitcnt lgkmcnt(5)
    v_mfma_f32_32x32x16_bf16 v[112:127], a[120:123], v[44:47], v[112:127]
    ds_read_b128 v[36:39], v8 offset:44032
    v_mfma_f32_32x32x16_bf16 v[128:143], a[124:127], v[44:47], v[128:143]
    s_waitcnt lgkmcnt(5)
    v_mfma_f32_32x32x16_bf16 v[112:127], a[128:131], v[16:19], v[112:127]
    ds_read_b128 v[40:43], v8 offset:46080
    v_mfma_f32_32x32x16_bf16 v[128:143], a[132:135], v[16:19], v[128:143]
    s_cmp_eq_u32 s85, 0
    s_cbranch_scc1 L_alt40
    s_waitcnt vmcnt(0)
    s_mov_b64 exec, 1
    buffer_store_dword v10, off, s[20:23], s90 offset:512
    s_mov_b64 exec, -1
L_join41:
    s_waitcnt lgkmcnt(5)
    v_mfma_f32_32x32x16_bf16 v[112:127], a[136:139], v[20:23], v[112:127]
    ds_read_b128 v[44:47], v8 offset:48128
    v_mfma_f32_32x32x16_bf16 v[128:143], a[140:143], v[20:23], v[128:143]
    s_waitcnt lgkmcnt(5)
    v_mfma_f32_32x32x16_bf16 v[112:127], a[144:147], v[24:27], v[112:127]
    ds_read_b128 v[16:19], v8 offset:50176
    v_mfma_f32_32x32x16_bf16 v[128:143], a[148:151], v[24:27], v[128:143]
    s_waitcnt lgkmcnt(5)
    v_mfma_f32_32x32x16_bf16 v[112:127], a[152:155], v[28:31], v[112:127]
    ds_read_b128 v[20:23], v8 offset:52224
    v_mfma_f32_32x32x16_bf16 v[128:143], a[156:159], v[28:31], v[128:143]
    s_waitcnt lgkmcnt(5)
    v_mfma_f32_32x32x16_bf16 v[112:127], a[160:163], v[32:35], v[112:127]
    ds_read_b128 v[24:27], v8 offset:54272
    v_mfma_f32_32x32x16_bf16 v[128:143], a[164:167], v[32:35], v[128:143]
    buffer_load_dword v14, v159, s[20:23], 0 offen offset:512 sc1
    s_waitcnt lgkmcnt(5)
    v_mfma_f32_32x32x16_bf16 v[112:127], a[168:171], v[36:39], v[112:127]
    ds_read_b128 v[28:31], v8 offset:56320
    v_mfma_f32_32x32x16_bf16 v[128:143], a[172:175], v[36:39], v[128:143]
    s_waitcnt lgkmcnt(5)
    v_mfma_f32_32x32x16_bf16 v[112:127], a[176:179], v[40:43], v[112:127]
    ds_read_b128 v[32:35], v8 offset:58368
    v_mfma_f32_32x32x16_bf16 v[128:143], a[180:183], v[40:43], v[128:143]
    s_waitcnt lgkmcnt(5)
    v_mfma_f32_32x32x16_bf16 v[112:127], a[184:187], v[44:47], v[112:127]
    ds_read_b128 v[36:39], v8 offset:60416
    v_mfma_f32_32x32x16_bf16 v[128:143], a[188:191], v[44:47], v[128:143]
    s_waitcnt lgkmcnt(5)
    v_mfma_f32_32x32x16_bf16 v[112:127], a[192:195], v[16:19], v[112:127]
    ds_read_b128 v[40:43], v8 offset:62464
    s_waitcnt vmcnt(0)
    v_cmp_ne_u32 vcc, s39, v14
    s_nop 0
    s_cmp_eq_u64 vcc, 0
    s_cbranch_scc0 L_xslow4
L_xok4:
    buffer_load_dwordx4 a[36:39], v11, s[32:35], s40 offen offset:0 sc1
    v_mfma_f32_32x32x16_bf16 v[128:143], a[196:199], v[16:19], v[128:143]
    buffer_load_dwordx4 a[40:43], v11, s[32:35], s40 offen offset:1024 sc1
    s_waitcnt lgkmcnt(5)
    v_mfma_f32_32x32x16_bf16 v[112:127], a[200:203], v[20:23], v[112:127]
    ds_read_b128 v[44:47], v8 offset:64512
    buffer_load_dwordx4 a[44:47], v11, s[32:35], s40 offen offset:2048 sc1
    v_mfma_f32_32x32x16_bf16 v[128:143], a[204:207], v[20:23], v[128:143]
    buffer_load_dwordx4 a[48:51], v11, s[32:35], s40 offen offset:3072 sc1
    s_waitcnt lgkmcnt(5)
    v_mfma_f32_32x32x16_bf16 v[112:127], a[208:211], v[24:27], v[112:127]
    buffer_load_dwordx4 a[52:55], v11, s[32:35], s41 offen offset:0 sc1
    v_mfma_f32_32x32x16_bf16 v[128:143], a[212:215], v[24:27], v[128:143]
    s_waitcnt lgkmcnt(4)
    v_mfma_f32_32x32x16_bf16 v[112:127], a[216:219], v[28:31], v[112:127]
    buffer_load_dwordx4 a[56:59], v11, s[32:35], s41 offen offset:1024 sc1
    v_mfma_f32_32x32x16_bf16 v[128:143], a[220:223], v[28:31], v[128:143]
    s_waitcnt lgkmcnt(3)
    v_mfma_f32_32x32x16_bf16 v[112:127], a[224:227], v[32:35], v[112:127]
    buffer_load_dwordx4 a[60:63], v11, s[32:35], s41 offen offset:2048 sc1
    v_mfma_f32_32x32x16_bf16 v[128:143], a[228:231], v[32:35], v[128:143]
    s_waitcnt lgkmcnt(2)
    v_mfma_f32_32x32x16_bf16 v[112:127], a[232:235], v[36:39], v[112:127]
    buffer_load_dwordx4 a[64:67], v11, s[32:35], s41 offen offset:3072 sc1
    v_mfma_f32_32x32x16_bf16 v[128:143], a[236:239], v[36:39], v[128:143]
    s_waitcnt lgkmcnt(1)
    v_mfma_f32_32x32x16_bf16 v[112:127], a[240:243], v[40:43], v[112:127]
    buffer_load_dwordx4 a[68:71], v11, s[32:35], s42 offen offset:0 sc1
    v_mfma_f32_32x32x16_bf16 v[128:143], a[244:247], v[40:43], v[128:143]
    s_barrier
    s_waitcnt lgkmcnt(0)
    v_mfma_f32_32x32x16_bf16 v[112:127], a[248:251], v[44:47], v[112:127]
    buffer_load_dwordx4 a[72:75], v11, s[32:35], s42 offen offset:1024 sc1
    v_mfma_f32_32x32x16_bf16 v[128:143], a[252:255], v[44:47], v[128:143]
    v_mfma_f32_32x32x16_bf16 v[112:127], v[48:51], v[60:63], v[112:127]
    v_mfma_f32_32x32x16_bf16 v[128:143], v[52:55], v[60:63], v[128:143]
    ds_read_b128 v[16:19], v15 offset:0
    ds_read_b128 v[20:23], v15 offset:1024
    ds_read_b128 v[24:27], v15 offset:2048
    buffer_load_dwordx4 a[76:79], v11, s[32:35], s42 offen offset:2048 sc1
    s_nop 6
    v_cvt_pk_bf16_f32 v64, v112, v113
    v_cvt_pk_bf16_f32 v65, v114, v115
    v_cvt_pk_bf16_f32 v66, v116, v117
    v_cvt_pk_bf16_f32 v67, v118, v119
    v_cvt_pk_bf16_f32 v68, v120, v121
    v_cvt_pk_bf16_f32 v69, v122, v123
    v_cvt_pk_bf16_f32 v70, v124, v125
    v_cvt_pk_bf16_f32 v71, v126, v127
    buffer_load_dwordx4 a[80:83], v11, s[32:35], s42 offen offset:3072 sc1
    v_pk_max_i16 v64, v64, 0
    v_pk_max_i16 v65, v65, 0
    v_pk_max_i16 v66, v66, 0
    v_pk_max_i16 v67, v67, 0
    v_pk_max_i16 v68, v68, 0
    v_pk_max_i16 v69, v69, 0
    v_pk_max_i16 v70, v70, 0
    v_pk_max_i16 v71, v71, 0
    v_cvt_pk_bf16_f32 v72, v128, v129
    v_cvt_pk_bf16_f32 v73, v130, v131
    v_cvt_pk_bf16_f32 v74, v132, v133
    v_cvt_pk_bf16_f32 v75, v134, v135
    v_cvt_pk_bf16_f32 v76, v136, v137
    v_cvt_pk_bf16_f32 v77, v138, v139
    v_cvt_pk_bf16_f32 v78, v140, v141
    v_cvt_pk_bf16_f32 v79, v142, v143
    v_pk_max_i16 v72, v72, 0
    v_pk_max_i16 v73, v73, 0
    v_pk_max_i16 v74, v74, 0
    v_pk_max_i16 v75, v75, 0
    v_pk_max_i16 v76, v76, 0
    v_pk_max_i16 v77, v77, 0
    v_pk_max_i16 v78, v78, 0
    v_pk_max_i16 v79, v79, 0
    s_cmp_eq_u32 s85, 0
    s_cbranch_scc1 L_alt44
    buffer_store_dwordx4 v[64:67], v6, s[32:35], s93 offen offset:0
    buffer_store_dwordx4 v[68:71], v6, s[32:35], s93 offen offset:1024
    buffer_store_dwordx4 v[72:75], v7, s[32:35], s93 offen offset:0
    buffer_store_dwordx4 v[76:79], v7, s[32:35], s93 offen offset:1024
L_join45:
    s_waitcnt vmcnt(15)
    s_waitcnt lgkmcnt(2)
    v_mfma_f32_32x32x16_bf16 v[80:95], v[16:19], a[36:39], 0
    ds_read_b128 v[28:31], v15 offset:3072
    buffer_load_dwordx4 a[84:87], v11, s[32:35], s43 offen offset:0 sc1
    v_mfma_f32_32x32x16_bf16 v[96:111], v[224:227], a[36:39], 0
    s_waitcnt vmcnt(15)
    s_waitcnt lgkmcnt(2)
    v_mfma_f32_32x32x16_bf16 v[80:95], v[20:23], a[40:43], v[80:95]
    ds_read_b128 v[16:19], v15 offset:4096
    buffer_load_dwordx4 a[88:91], v11, s[32:35], s43 offen offset:1024 sc1
    v_mfma_f32_32x32x16_bf16 v[96:111], v[228:231], a[40:43], v[96:111]
    s_waitcnt vmcnt(15)
    s_waitcnt lgkmcnt(2)
    v_mfma_f32_32x32x16_bf16 v[80:95], v[24:27], a[44:47], v[80:95]
    ds_read_b128 v[20:23], v15 offset:5120
    buffer_load_dwordx4 a[92:95], v11, s[32:35], s43 offen offset:2048 sc1
    v_mfma_f32_32x32x16_bf16 v[96:111], v[232:235], a[44:47], v[96:111]
    s_waitcnt vmcnt(15)
    s_waitcnt lgkmcnt(2)
    v_mfma_f32_32x32x16_bf16 v[80:95], v[28:31], a[48:51], v[80:95]
    ds_read_b128 v[24:27], v15 offset:6144
    buffer_load_dwordx4 a[96:99], v11, s[32:35], s43 offen offset:3072 sc1
    v_mfma_f32_32x32x16_bf16 v[96:111], v[236:239], a[48:51], v[96:111]
    s_waitcnt vmcnt(15)
    s_waitcnt lgkmcnt(2)
    v_mfma_f32_32x32x16_bf16 v[80:95], v[16:19], a[52:55], v[80:95]
    ds_read_b128 v[28:31], v15 offset:7168
    buffer_load_dwordx4 a[100:103], v11, s[32:35], s44 offen offset:0 sc1
    v_mfma_f32_32x32x16_bf16 v[96:111], v[240:243], a[52:55], v[96:111]
    s_waitcnt vmcnt(15)
    s_waitcnt lgkmcnt(2)
    v_mfma_f32_32x32x16_bf16 v[80:95], v[20:23], a[56:59], v[80:95]
    ds_read_b128 v[16:19], v15 offset:8192
    buffer_load_dwordx4 a[104:107], v11, s[32:35], s44 offen offset:1024 sc1
    v_mfma_f32_32x32x16_bf16 v[96:111], v[244:247], a[56:59], v[96:111]
    s_waitcnt vmcnt(15)
    s_waitcnt lgkmcnt(2)
    v_mfma_f32_32x32x16_bf16 v[80:95], v[24:27], a[60:63], v[80:95]
    ds_read_b128 v[20:23], v15 offset:9216
    buffer_load_dwordx4 a[108:111], v11, s[32:35], s44 offen offset:2048 sc1
    v_mfma_f32_32x32x16_bf16 v[96:111], v[248:251], a[60:63], v[96:111]
    s_cmp_eq_u32 s85, 0
    s_cbranch_scc1 L_alt46
    s_waitcnt vmcnt(7)
    s_mov_b64 exec, 1
    buffer_store_dword v10, off, s[20:23], s90 offset:640
    s_mov_b64 exec, -1
L_join47:
    s_waitcnt lgkmcnt(2)
    v_mfma_f32_32x32x16_bf16 v[80:95], v[28:31], a[64:67], v[80:95]
    ds_read_b128 v[24:27], v15 offset:10240
    buffer_load_dwordx4 a[112:115], v11, s[32:35], s44 offen offset:3072 sc1
    v_mfma_f32_32x32x16_bf16 v[96:111], v[252:255], a[64:67], v[96:111]
    s_waitcnt lgkmcnt(2)
    v_mfma_f32_32x32x16_bf16 v[80:95], v[16:19], a[68:71], v[80:95]
    ds_read_b128 v[28:31], v15 offset:11264
    buffer_load_dwordx4 a[116:119], v11, s[32:35], s45 offen offset:0 sc1
    v_mfma_f32_32x32x16_bf16 v[96:111], v[160:163], a[68:71], v[96:111]
    s_waitcnt lgkmcnt(2)
    v_mfma_f32_32x32x16_bf16 v[80:95], v[20:23], a[72:75], v[80:95]
    ds_read_b128 v[16:19], v15 offset:12288
    buffer_load_dwordx4 a[120:123], v11, s[32:35], s45 offen offset:1024 sc1
    v_mfma_f32_32x32x16_bf16 v[96:111], v[164:167], a[72:75], v[96:111]
    s_waitcnt lgkmcnt(2)
    v_mfma_f32_32x32x16_bf16 v[80:95], v[24:27], a[76:79], v[80:95]
    ds_read_b128 v[20:23], v15 offset:13312
    buffer_load_dwordx4 a[124:127], v11, s[32:35], s45 offen offset:2048 sc1
    v_mfma_f32_32x32x16_bf16 v[96:111], v[168:171], a[76:79], v[96:111]
    s_waitcnt lgkmcnt(2)
    v_mfma_f32_32x32x16_bf16 v[80:95], v[28:31], a[80:83], v[80:95]
    ds_read_b128 v[24:27], v15 offset:14336
    buffer_load_dwordx4 a[128:131], v11, s[32:35], s45 offen offset:3072 sc1
    v_mfma_f32_32x32x16_bf16 v[96:111], v[172:175], a[80:83], v[96:111]
    s_waitcnt vmcnt(12)
    s_waitcnt lgkmcnt(2)
    v_mfma_f32_32x32x16_bf16 v[80:95], v[16:19], a[84:87], v[80:95]
    ds_read_b128 v[28:31], v15 offset:15360
    buffer_load_dwordx4 a[132:135], v11, s[32:35], s46 offen offset:0 sc1
    v_mfma_f32_32x32x16_bf16 v[96:111], v[176:179], a[84:87], v[96:111]
    s_waitcnt vmcnt(12)
    s_waitcnt lgkmcnt(2)
    v_mfma_f32_32x32x16_bf16 v[80:95], v[20:23], a[88:91], v[80:95]
    ds_read_b128 v[16:19], v15 offset:16384
    buffer_load_dwordx4 a[136:139], v11, s[32:35], s46 offen offset:1024 sc1
    v_mfma_f32_32x32x16_bf16 v[96:111], v[180:183], a[88:91], v[96:111]
    s_waitcnt vmcnt(12)
    s_waitcnt lgkmcnt(2)
    v_mfma_f32_32x32x16_bf16 v[80:95], v[24:27], a[92:95], v[80:95]
    ds_read_b128 v[20:23], v15 offset:17408
    buffer_load_dwordx4 a[140:143], v11, s[32:35], s46 offen offset:2048 sc1
    v_mfma_f32_32x32x16_bf16 v[96:111], v[184:187], a[92:95], v[96:111]
    s_waitcnt vmcnt(12)
    s_waitcnt lgkmcnt(2)
    v_mfma_f32_32x32x16_bf16 v[80:95], v[28:31], a[96:99], v[80:95]
    ds_read_b128 v[24:27], v15 offset:18432
    buffer_load_dwordx4 a[144:147], v11, s[32:35], s46 offen offset:3072 sc1
    v_mfma_f32_32x32x16_bf16 v[96:111], v[188:191], a[96:99], v[96:111]
    s_waitcnt vmcnt(12)
    s_waitcnt lgkmcnt(2)
    v_mfma_f32_32x32x16_bf16 v[80:95], v[16:19], a[100:103], v[80:95]
    ds_read_b128 v[28:31], v15 offset:19456
    v_mfma_f32_32x32x16_bf16 v[96:111], v[192:195], a[100:103], v[96:111]
    s_waitcnt vmcnt(11)
    s_waitcnt lgkmcnt(2)
    v_mfma_f32_32x32x16_bf16 v[80:95], v[20:23], a[104:107], v[80:95]
    ds_read_b128 v[16:19], v15 offset:20480
    v_mfma_f32_32x32x16_bf16 v[96:111], v[196:199], a[104:107], v[96:111]
    buffer_load_dword v14, v159, s[20:23], 0 offen offset:640 sc1
    s_waitcnt vmcnt(11)
    s_waitcnt lgkmcnt(2)
    v_mfma_f32_32x32x16_bf16 v[80:95], v[24:27], a[108:111], v[80:95]
    ds_read_b128 v[20:23], v15 offset:21504
    v_mfma_f32_32x32x16_bf16 v[96:111], v[200:203], a[108:111], v[96:111]
    s_waitcnt vmcnt(9)
    s_waitcnt lgkmcnt(2)
    v_mfma_f32_32x32x16_bf16 v[80:95], v[28:31], a[112:115], v[80:95]
    ds_read_b128 v[24:27], v15 offset:22528
    v_mfma_f32_32x32x16_bf16 v[96:111], v[204:207], a[112:115], v[96:111]
    s_waitcnt vmcnt(8)
    s_waitcnt lgkmcnt(2)
    v_mfma_f32_32x32x16_bf16 v[80:95], v[16:19], a[116:119], v[80:95]
    ds_read_b128 v[28:31], v15 offset:0
    v_mfma_f32_32x32x16_bf16 v[96:111], v[208:211], a[116:119], v[96:111]
    s_waitcnt vmcnt(7)
    s_waitcnt lgkmcnt(2)
    v_mfma_f32_32x32x16_bf16 v[80:95], v[20:23], a[120:123], v[80:95]
    ds_read_b128 v[16:19], v15 offset:1024
    v_mfma_f32_32x32x16_bf16 v[96:111], v[212:215], a[120:123], v[96:111]
    s_waitcnt vmcnt(0)
    v_cmp_ne_u32 vcc, s39, v14
    s_nop 0
    s_cmp_eq_u64 vcc, 0
    s_cbranch_scc0 L_xslow5
L_xok5:
    s_waitcnt lgkmcnt(2)
    v_mfma_f32_32x32x16_bf16 v[80:95], v[24:27], a[124:127], v[80:95]
    ds_read_b128 v[20:23], v15 offset:2048
    v_add_u32 v11, s93, v11
    buffer_load_dwordx4 a[148:151], v11, s[32:35], s40 offen offset:0 sc1
    v_mfma_f32_32x32x16_bf16 v[96:111], v[216:219], a[124:127], v[96:111]
    buffer_load_dwordx4 a[152:155], v11, s[32:35], s40 offen offset:1024 sc1
    v_mfma_f32_32x32x16_bf16 v[80:95], v[220:223], a[128:131], v[80:95]
    buffer_load_dwordx4 a[156:159], v11, s[32:35], s40 offen offset:2048 sc1
    v_mfma_f32_32x32x16_bf16 v[96:111], a[0:3], a[128:131], v[96:111]
    buffer_load_dwordx4 a[160:163], v11, s[32:35], s40 offen offset:3072 sc1
    v_mfma_f32_32x32x16_bf16 v[80:95], a[4:7], a[132:135], v[80:95]
    buffer_load_dwordx4 a[164:167], v11, s[32:35], s41 offen offset:0 sc1
    v_mfma_f32_32x32x16_bf16 v[96:111], a[8:11], a[132:135], v[96:111]
    v_mfma_f32_32x32x16_bf16 v[80:95], a[12:15], a[136:139], v[80:95]
    buffer_load_dwordx4 a[168:171], v11, s[32:35], s41 offen offset:1024 sc1
    v_mfma_f32_32x32x16_bf16 v[96:111], a[16:19], a[136:139], v[96:111]
    v_mfma_f32_32x32x16_bf16 v[80:95], a[20:23], a[140:143], v[80:95]
    buffer_load_dwordx4 a[172:175], v11, s[32:35], s41 offen offset:2048 sc1
    v_mfma_f32_32x32x16_bf16 v[96:111], a[24:27], a[140:143], v[96:111]
    v_mfma_f32_32x32x16_bf16 v[80:95], a[28:31], a[144:147], v[80:95]
    buffer_load_dwordx4 a[176:179], v11, s[32:35], s41 offen offset:3072 sc1
    v_mfma_f32_32x32x16_bf16 v[96:111], a[32:35], a[144:147], v[96:111]
    s_barrier
    s_waitcnt vmcnt(7)
    s_waitcnt lgkmcnt(2)
    v_mfma_f32_32x32x16_bf16 v[112:127], v[28:31], a[148:151], 0
    ds_read_b128 v[24:27], v15 offset:3072
    buffer_load_dwordx4 a[180:183], v11, s[32:35], s42 offen offset:0 sc1
    v_mfma_f32_32x32x16_bf16 v[128:143], v[224:227], a[148:151], 0
    s_waitcnt vmcnt(7)
    s_waitcnt lgkmcnt(2)
    v_mfma_f32_32x32x16_bf16 v[112:127], v[16:19], a[152:155], v[112:127]
    ds_read_b128 v[28:31], v15 offset:4096
    buffer_load_dwordx4 a[184:187], v11, s[32:35], s42 offen offset:1024 sc1
    ds_write_b128 v2, v[84:87] offset:0
    v_mfma_f32_32x32x16_bf16 v[128:143], v[228:231], a[152:155], v[128:143]
    ds_write_b128 v3, v[88:91] offset:0
    s_waitcnt vmcnt(7)
    s_waitcnt lgkmcnt(4)
    v_mfma_f32_32x32x16_bf16 v[112:127], v[20:23], a[156:159], v[112:127]
    ds_read_b128 v[16:19], v15 offset:5120
    buffer_load_dwordx4 a[188:191], v11, s[32:35], s42 offen offset:2048 sc1
    ds_write_b128 v4, v[92:95] offset:0
    v_mfma_f32_32x32x16_bf16 v[128:143], v[232:235], a[156:159], v[128:143]
    ds_write_b128 v2, v[100:103] offset:2048
    s_waitcnt vmcnt(7)
    s_waitcnt lgkmcnt(6)
    v_mfma_f32_32x32x16_bf16 v[112:127], v[24:27], a[160:163], v[112:127]
    ds_read_b128 v[20:23], v15 offset:6144
    buffer_load_dwordx4 a[192:195], v11, s[32:35], s42 offen offset:3072 sc1
    ds_write_b128 v3, v[104:107] offset:2048
    v_mfma_f32_32x32x16_bf16 v[128:143], v[236:239], a[160:163], v[128:143]
    ds_write_b128 v4, v[108:111] offset:2048
    s_waitcnt vmcnt(7)
    s_waitcnt lgkmcnt(8)
    v_mfma_f32_32x32x16_bf16 v[112:127], v[28:31], a[164:167], v[112:127]
    ds_read_b128 v[24:27], v15 offset:7168
    buffer_load_dwordx4 a[196:199], v11, s[32:35], s43 offen offset:0 sc1
    v_mfma_f32_32x32x16_bf16 v[128:143], v[240:243], a[164:167], v[128:143]
    s_waitcnt vmcnt(7)
    s_waitcnt lgkmcnt(6)
    v_mfma_f32_32x32x16_bf16 v[112:127], v[16:19], a[168:171], v[112:127]
    ds_read_b128 v[28:31], v15 offset:8192
    buffer_load_dwordx4 a[200:203], v11, s[32:35], s43 offen offset:1024 sc1
    v_mfma_f32_32x32x16_bf16 v[128:143], v[244:247], a[168:171], v[128:143]
    s_waitcnt vmcnt(7)
    s_waitcnt lgkmcnt(4)
    v_mfma_f32_32x32x16_bf16 v[112:127], v[20:23], a[172:175], v[112:127]
    ds_read_b128 v[16:19], v15 offset:9216
    buffer_load_dwordx4 a[204:207], v11, s[32:35], s43 offen offset:2048 sc1
    v_mfma_f32_32x32x16_bf16 v[128:143], v[248:251], a[172:175], v[128:143]
    s_waitcnt vmcnt(7)
    s_waitcnt lgkmcnt(2)
    v_mfma_f32_32x32x16_bf16 v[112:127], v[24:27], a[176:179], v[112:127]
    ds_read_b128 v[20:23], v15 offset:10240
    buffer_load_dwordx4 a[208:211], v11, s[32:35], s43 offen offset:3072 sc1
    s_barrier
    ds_read_b128 v[32:35], v5 offset:0
    v_mfma_f32_32x32x16_bf16 v[128:143], v[252:255], a[176:179], v[128:143]
    ds_read_b128 v[36:39], v5 offset:2048
    s_waitcnt vmcnt(7)
    s_waitcnt lgkmcnt(4)
    v_mfma_f32_32x32x16_bf16 v[112:127], v[28:31], a[180:183], v[112:127]
    ds_read_b128 v[24:27], v15 offset:11264
    buffer_load_dwordx4 a[212:215], v11, s[32:35], s44 offen offset:0 sc1
    ds_read_b128 v[40:43], v5 offset:4096
    v_mfma_f32_32x32x16_bf16 v[128:143], v[160:163], a[180:183], v[128:143]
    ds_read_b128 v[44:47], v5 offset:6144
    s_waitcnt vmcnt(7)
    s_waitcnt lgkmcnt(6)
    v_mfma_f32_32x32x16_bf16 v[112:127], v[16:19], a[184:187], v[112:127]
    ds_read_b128 v[28:31], v15 offset:12288
    buffer_load_dwordx4 a[216:219], v11, s[32:35], s44 offen offset:1024 sc1
    ds_read_b128 v[48:51], v5 offset:8192
    v_lshlrev_b32 v224, 16, v144
    v_and_b32 v228, 0xffff0000, v144
    v_mfma_f32_32x32x16_bf16 v[128:143], v[164:167], a[184:187], v[128:143]
    ds_read_b128 v[52:55], v5 offset:10240
    v_lshlrev_b32 v225, 16, v145
    v_and_b32 v229, 0xffff0000, v145
    s_waitcnt vmcnt(7)
    s_waitcnt lgkmcnt(8)
    v_mfma_f32_32x32x16_bf16 v[112:127], v[20:23], a[188:191], v[112:127]
    ds_read_b128 v[16:19], v15 offset:13312
    buffer_load_dwordx4 a[220:223], v11, s[32:35], s44 offen offset:2048 sc1
    v_lshlrev_b32 v226, 16, v146
    v_and_b32 v230, 0xffff0000, v146
    v_mfma_f32_32x32x16_bf16 v[128:143], v[168:171], a[188:191], v[128:143]
    v_lshlrev_b32 v227, 16, v147
    v_and_b32 v231, 0xffff0000, v147
    s_waitcnt vmcnt(7)
    s_waitcnt lgkmcnt(6)
    v_mfma_f32_32x32x16_bf16 v[112:127], v[24:27], a[192:195], v[112:127]
    ds_read_b128 v[20:23], v15 offset:14336
    buffer_load_dwordx4 a[224:227], v11, s[32:35], s44 offen offset:3072 sc1
    v_lshlrev_b32 v232, 16, v148
    v_and_b32 v236, 0xffff0000, v148
    v_mfma_f32_32x32x16_bf16 v[128:143], v[172:175], a[192:195], v[128:143]
    v_lshlrev_b32 v233, 16, v149
    v_and_b32 v237, 0xffff0000, v149
    s_waitcnt vmcnt(7)
    s_waitcnt lgkmcnt(4)
    v_mfma_f32_32x32x16_bf16 v[112:127], v[28:31], a[196:199], v[112:127]
    ds_read_b128 v[24:27], v15 offset:15360
    buffer_load_dwordx4 a[228:231], v11, s[32:35], s45 offen offset:0 sc1
    v_lshlrev_b32 v234, 16, v150
    v_and_b32 v238, 0xffff0000, v150
    v_mfma_f32_32x32x16_bf16 v[128:143], v[176:179], a[196:199], v[128:143]
    v_lshlrev_b32 v235, 16, v151
    v_and_b32 v239, 0xffff0000, v151
    s_waitcnt vmcnt(7)
    s_waitcnt lgkmcnt(2)
    v_mfma_f32_32x32x16_bf16 v[112:127], v[16:19], a[200:203], v[112:127]
    ds_read_b128 v[28:31], v15 offset:16384
    buffer_load_dwordx4 a[232:235], v11, s[32:35], s45 offen offset:1024 sc1
    v_add_f32 v80, v80, v32
    v_add_f32 v81, v81, v33
    v_mfma_f32_32x32x16_bf16 v[128:143], v[180:183], a[200:203], v[128:143]
    v_add_f32 v82, v82, v34
    v_add_f32 v83, v83, v35
    s_waitcnt vmcnt(7)
    s_waitcnt lgkmcnt(2)
    v_mfma_f32_32x32x16_bf16 v[112:127], v[20:23], a[204:207], v[112:127]
    ds_read_b128 v[16:19], v15 offset:17408
    buffer_load_dwordx4 a[236:239], v11, s[32:35], s45 offen offset:2048 sc1
    v_add_f32 v96, v96, v36
    v_add_f32 v97, v97, v37
    v_mfma_f32_32x32x16_bf16 v[128:143], v[184:187], a[204:207], v[128:143]
    v_add_f32 v98, v98, v38
    v_add_f32 v99, v99, v39
    s_waitcnt vmcnt(7)
    s_waitcnt lgkmcnt(2)
    v_mfma_f32_32x32x16_bf16 v[112:127], v[24:27], a[208:211], v[112:127]
    ds_read_b128 v[20:23], v15 offset:18432
    buffer_load_dwordx4 a[240:243], v11, s[32:35], s45 offen offset:3072 sc1
    v_add_f32 v80, v80, v40
    v_add_f32 v81, v81, v41
    v_mfma_f32_32x32x16_bf16 v[128:143], v[188:191], a[208:211], v[128:143]
    v_add_f32 v82, v82, v42
    v_add_f32 v83, v83, v43
    s_waitcnt vmcnt(7)
    s_waitcnt lgkmcnt(2)
    v_mfma_f32_32x32x16_bf16 v[112:127], v[28:31], a[212:215], v[112:127]
    ds_read_b128 v[24:27], v15 offset:19456
    buffer_load_dwordx4 a[244:247], v11, s[32:35], s46 offen offset:0 sc1
    v_add_f32 v96, v96, v44
    v_add_f32 v97, v97, v45
    v_mfma_f32_32x32x16_bf16 v[128:143], v[192:195], a[212:215], v[128:143]
    v_add_f32 v98, v98, v46
    v_add_f32 v99, v99, v47
    s_waitcnt vmcnt(7)
    s_waitcnt lgkmcnt(2)
    v_mfma_f32_32x32x16_bf16 v[112:127], v[16:19], a[216:219], v[112:127]
    ds_read_b128 v[28:31], v15 offset:20480
    buffer_load_dwordx4 a[248:251], v11, s[32:35], s46 offen offset:1024 sc1
    v_add_f32 v80, v80, v48
    v_add_f32 v81, v81, v49
    v_mfma_f32_32x32x16_bf16 v[128:143], v[196:199], a[216:219], v[128:143]
    v_add_f32 v82, v82, v50
    v_add_f32 v83, v83, v51
    s_waitcnt vmcnt(7)
    s_waitcnt lgkmcnt(2)
    v_mfma_f32_32x32x16_bf16 v[112:127], v[20:23], a[220:223], v[112:127]
    ds_read_b128 v[16:19], v15 offset:21504
    buffer_load_dwordx4 a[252:255], v11, s[32:35], s46 offen offset:2048 sc1
    v_add_f32 v96, v96, v52
    v_add_f32 v97, v97, v53
    v_mfma_f32_32x32x16_bf16 v[128:143], v[200:203], a[220:223], v[128:143]
    v_add_f32 v98, v98, v54
    v_add_f32 v99, v99, v55
    s_waitcnt vmcnt(7)
    s_waitcnt lgkmcnt(2)
    v_mfma_f32_32x32x16_bf16 v[112:127], v[24:27], a[224:227], v[112:127]
    ds_read_b128 v[20:23], v15 offset:22528
    buffer_load_dwordx4 a[36:39], v11, s[32:35], s46 offen offset:3072 sc1
    v_fma_f32 v80, v80, v154, v224
    v_fma_f32 v96, v96, v154, v228
    v_mfma_f32_32x32x16_bf16 v[128:143], v[204:207], a[224:227], v[128:143]
    v_fma_f32 v81, v81, v154, v225
    v_fma_f32 v97, v97, v154, v229
    s_waitcnt vmcnt(7)
    s_waitcnt lgkmcnt(2)
    v_mfma_f32_32x32x16_bf16 v[112:127], v[28:31], a[228:231], v[112:127]
    v_fma_f32 v82, v82, v154, v226
    v_fma_f32 v98, v98, v154, v230
    v_mfma_f32_32x32x16_bf16 v[128:143], v[208:211], a[228:231], v[128:143]
    v_fma_f32 v83, v83, v154, v227
    v_fma_f32 v99, v99, v154, v231
    s_waitcnt vmcnt(6)
    s_waitcnt lgkmcnt(1)
    v_mfma_f32_32x32x16_bf16 v[112:127], v[16:19], a[232:235], v[112:127]
    v_cvt_pk_bf16_f32 v144, v80, v96
    v_cvt_pk_bf16_f32 v145, v81, v97
    v_mfma_f32_32x32x16_bf16 v[128:143], v[212:215], a[232:235], v[128:143]
    v_cvt_pk_bf16_f32 v146, v82, v98
    v_cvt_pk_bf16_f32 v147, v83, v99
    buffer_store_dwordx4 v[144:147], v155, s[28:31], 0 offen
    s_waitcnt vmcnt(6)
    s_waitcnt lgkmcnt(0)
    v_mfma_f32_32x32x16_bf16 v[112:127], v[20:23], a[236:239], v[112:127]
    v_mfma_f32_32x32x16_bf16 v[128:143], v[216:219], a[236:239], v[128:143]
    s_waitcnt vmcnt(5)
    v_mfma_f32_32x32x16_bf16 v[112:127], v[220:223], a[240:243], v[112:127]
    v_mfma_f32_32x32x16_bf16 v[128:143], a[0:3], a[240:243], v[128:143]
    s_waitcnt vmcnt(4)
    v_mfma_f32_32x32x16_bf16 v[112:127], a[4:7], a[244:247], v[112:127]
    v_mfma_f32_32x32x16_bf16 v[128:143], a[8:11], a[244:247], v[128:143]
    s_waitcnt vmcnt(3)
    v_mfma_f32_32x32x16_bf16 v[112:127], a[12:15], a[248:251], v[112:127]
    v_mfma_f32_32x32x16_bf16 v[128:143], a[16:19], a[248:251], v[128:143]
    s_waitcnt vmcnt(2)
    v_mfma_f32_32x32x16_bf16 v[112:127], a[20:23], a[252:255], v[112:127]
    v_mfma_f32_32x32x16_bf16 v[128:143], a[24:27], a[252:255], v[128:143]
    s_waitcnt vmcnt(1)
    v_mfma_f32_32x32x16_bf16 v[112:127], a[28:31], a[36:39], v[112:127]
    v_mfma_f32_32x32x16_bf16 v[128:143], a[32:35], a[36:39], v[128:143]
    s_nop 10
    ds_write_b128 v2, v[116:119] offset:1024
    ds_write_b128 v3, v[120:123] offset:1024
    ds_write_b128 v4, v[124:127] offset:1024
    ds_write_b128 v2, v[132:135] offset:3072
    ds_write_b128 v3, v[136:139] offset:3072
    ds_write_b128 v4, v[140:143] offset:3072
    s_waitcnt lgkmcnt(0)
    s_barrier
    ds_read_b128 v[32:35], v5 offset:1024
    ds_read_b128 v[36:39], v5 offset:3072
    ds_read_b128 v[40:43], v5 offset:5120
    ds_read_b128 v[44:47], v5 offset:7168
    ds_read_b128 v[48:51], v5 offset:9216
    ds_read_b128 v[52:55], v5 offset:11264
    s_waitcnt lgkmcnt(5)
    v_pk_add_f32 v[112:113], v[112:113], v[32:33]
    v_pk_add_f32 v[114:115], v[114:115], v[34:35]
    s_waitcnt lgkmcnt(4)
    v_pk_add_f32 v[128:129], v[128:129], v[36:37]
    v_pk_add_f32 v[130:131], v[130:131], v[38:39]
    s_waitcnt lgkmcnt(3)
    v_pk_add_f32 v[112:113], v[112:113], v[40:41]
    v_pk_add_f32 v[114:115], v[114:115], v[42:43]
    s_waitcnt lgkmcnt(2)
    v_pk_add_f32 v[128:129], v[128:129], v[44:45]
    v_pk_add_f32 v[130:131], v[130:131], v[46:47]
    s_waitcnt lgkmcnt(1)
    v_pk_add_f32 v[112:113], v[112:113], v[48:49]
    v_pk_add_f32 v[114:115], v[114:115], v[50:51]
    s_waitcnt lgkmcnt(0)
    v_pk_add_f32 v[128:129], v[128:129], v[52:53]
    v_pk_add_f32 v[130:131], v[130:131], v[54:55]
    v_fma_f32 v112, v112, v1, v232
    v_fma_f32 v128, v128, v1, v236
    v_fma_f32 v113, v113, v1, v233
    v_fma_f32 v129, v129, v1, v237
    v_fma_f32 v114, v114, v1, v234
    v_fma_f32 v130, v130, v1, v238
    v_fma_f32 v115, v115, v1, v235
    v_fma_f32 v131, v131, v1, v239
    v_cvt_pk_bf16_f32 v148, v112, v128
    v_cvt_pk_bf16_f32 v149, v113, v129
    v_cvt_pk_bf16_f32 v150, v114, v130
    v_cvt_pk_bf16_f32 v151, v115, v131
    buffer_store_dwordx4 v[148:151], v155, s[28:31], s79 offen
    s_or_b32 s86, s2, s36
    s_cmp_eq_u32 s86, 0
    s_cbranch_scc0 L_noepoch
    s_mov_b64 exec, 1
    buffer_store_dword v10, off, s[20:23], 0 sc1
    s_mov_b64 exec, -1
L_noepoch:
    s_endpgm
L_fin:
    v_add_u32 v11, 143360, v8
    ds_read_b128 v[32:35], v11 offset:4096
    ds_read_b128 v[36:39], v11 offset:8192
    ds_read_b128 v[40:43], v11 offset:12288
    v_lshlrev_b32 v11, 4, v192
    v_add_u32 v11, 159744, v11
    v_lshlrev_b32 v12, 6, v193
    v_add_u32 v12, 159744, v12
    s_mov_b32 s94, 0x3b000000
    s_lshl_b32 s86, s38, 1
    s_lshr_b32 s87, s92, 1
    s_add_u32 s86, s86, s87
    s_mul_i32 s88, s86, 2112
    s_and_b32 s87, s92, 1
    v_and_b32 v44, 1, v193
    v_lshlrev_b32 v44, 3, v44
    v_lshrrev_b32 v45, 1, v193
    s_bitcmp0_b32 s37, 0
    s_cbranch_scc0 L_finv
    ds_read_b128 v[64:67], v11
    ds_read_b128 v[68:71], v11 offset:512
    ds_read_b128 v[72:75], v12 offset:256
    ds_read_b128 v[76:79], v12 offset:272
    ds_read_b128 v[80:83], v12 offset:288
    ds_read_b128 v[84:87], v12 offset:304
    v_lshl_add_u32 v45, v45, 5, v192
    v_lshl_add_u32 v44, v45, 4, v44
    s_lshl_b32 s87, s87, 8
    s_add_u32 s88, s88, s87
    s_waitcnt lgkmcnt(6)
    v_add_f32 v16, v16, v32
    v_add_f32 v36, v36, v40
    v_add_f32 v17, v17, v33
    v_add_f32 v37, v37, v41
    v_add_f32 v18, v18, v34
    v_add_f32 v38, v38, v42
    v_add_f32 v19, v19, v35
    v_add_f32 v39, v39, v43
    v_add_f32 v16, v16, v36
    v_add_f32 v17, v17, v37
    v_add_f32 v18, v18, v38
    v_add_f32 v19, v19, v39
    s_waitcnt lgkmcnt(4)
    v_add_f32 v64, v64, v65
    v_add_f32 v66, v66, v67
    v_add_f32 v64, v64, v66
    v_add_f32 v68, v68, v69
    v_add_f32 v70, v70, v71
    v_add_f32 v68, v68, v70
    v_mul_f32 v64, 0xbb000000, v64
    v_mul_f32 v65, v64, v64
    v_fma_f32 v65, v68, s94, -v65
    v_max_f32 v65, 0, v65
    v_add_f32 v65, 0x3727c5ac, v65
    v_rsq_f32 v65, v65
    s_waitcnt lgkmcnt(0)
    v_add_f32 v72, v72, v73
    v_add_f32 v74, v74, v75
    v_add_f32 v72, v72, v74
    v_add_f32 v76, v76, v77
    v_add_f32 v78, v78, v79
    v_add_f32 v76, v76, v78
    v_add_f32 v80, v80, v81
    v_add_f32 v82, v82, v83
    v_add_f32 v80, v80, v82
    v_add_f32 v84, v84, v85
    v_add_f32 v86, v86, v87
    v_add_f32 v84, v84, v86
    v_fma_f32 v16, v64, v72, v16
    v_fma_f32 v17, v64, v76, v17
    v_fma_f32 v18, v64, v80, v18
    v_fma_f32 v19, v64, v84, v19
    v_mul_f32 v16, v16, v65
    v_mul_f32 v17, v17, v65
    v_mul_f32 v18, v18, v65
    v_mul_f32 v19, v19, v65
    s_branch L_finst
L_finv:
    ds_read_b128 v[64:67], v11 offset:256
    ds_read_b128 v[68:71], v12 offset:0
    ds_read_b128 v[72:75], v12 offset:512
    ds_read_b128 v[76:79], v12 offset:16
    ds_read_b128 v[80:83], v12 offset:528
    ds_read_b128 v[84:87], v12 offset:32
    ds_read_b128 v[88:91], v12 offset:544
    ds_read_b128 v[92:95], v12 offset:48
    ds_read_b128 v[96:99], v12 offset:560
    s_mul_i32 s87, s87, 544
    s_add_u32 s88, s88, s87
    s_add_u32 s88, s88, 1024
    v_mul_u32_u24 v45, 272, v45
    v_add_u32 v45, v45, v44
    v_lshl_add_u32 v44, v192, 4, v45
    s_mov_b32 exec_lo, 0x00010001
    s_mov_b32 exec_hi, 0x00010001
    buffer_store_dwordx2 v[56:57], v45, s[24:27], s88 offen offset:256 sc1
    s_mov_b64 exec, -1
    s_waitcnt lgkmcnt(9)
    v_add_f32 v16, v16, v32
    v_add_f32 v36, v36, v40
    v_add_f32 v17, v17, v33
    v_add_f32 v37, v37, v41
    v_add_f32 v18, v18, v34
    v_add_f32 v38, v38, v42
    v_add_f32 v19, v19, v35
    v_add_f32 v39, v39, v43
    v_add_f32 v16, v16, v36
    v_add_f32 v17, v17, v37
    v_add_f32 v18, v18, v38
    v_add_f32 v19, v19, v39
    s_waitcnt lgkmcnt(8)
    v_add_f32 v64, v64, v65
    v_add_f32 v66, v66, v67
    v_add_f32 v64, v64, v66
    s_waitcnt lgkmcnt(6)
    v_add_f32 v68, v68, v69
    v_add_f32 v70, v70, v71
    v_add_f32 v68, v68, v70
    v_add_f32 v72, v72, v73
    v_add_f32 v74, v74, v75
    v_add_f32 v72, v72, v74
    v_mul_f32 v68, 0xbb000000, v68
    v_mul_f32 v69, v68, v68
    v_fma_f32 v69, v72, s94, -v69
    v_max_f32 v69, 0, v69
    v_add_f32 v69, 0x3727c5ac, v69
    v_rsq_f32 v69, v69
    v_fma_f32 v16, v68, v64, v16
    v_mul_f32 v16, v16, v69
    s_waitcnt lgkmcnt(4)
    v_add_f32 v76, v76, v77
    v_add_f32 v78, v78, v79
    v_add_f32 v76, v76, v78
    v_add_f32 v80, v80, v81
    v_add_f32 v82, v82, v83
    v_add_f32 v80, v80, v82
    v_mul_f32 v76, 0xbb000000, v76
    v_mul_f32 v77, v76, v76
    v_fma_f32 v77, v80, s94, -v77
    v_max_f32 v77, 0, v77
    v_add_f32 v77, 0x3727c5ac, v77
    v_rsq_f32 v77, v77
    v_fma_f32 v17, v76, v64, v17
    v_mul_f32 v17, v17, v77
    s_waitcnt lgkmcnt(2)
    v_add_f32 v84, v84, v85
    v_add_f32 v86, v86, v87
    v_add_f32 v84, v84, v86
    v_add_f32 v88, v88, v89
    v_add_f32 v90, v90, v91
    v_add_f32 v88, v88, v90
    v_mul_f32 v84, 0xbb000000, v84
    v_mul_f32 v85, v84, v84
    v_fma_f32 v85, v88, s94, -v85
    v_max_f32 v85, 0, v85
    v_add_f32 v85, 0x3727c5ac, v85
    v_rsq_f32 v85, v85
    v_fma_f32 v18, v84, v64, v18
    v_mul_f32 v18, v18, v85
    s_waitcnt lgkmcnt(0)
    v_add_f32 v92, v92, v93
    v_add_f32 v94, v94, v95
    v_add_f32 v92, v92, v94
    v_add_f32 v96, v96, v97
    v_add_f32 v98, v98, v99
    v_add_f32 v96, v96, v98
    v_mul_f32 v92, 0xbb000000, v92
    v_mul_f32 v93, v92, v92
    v_fma_f32 v93, v96, s94, -v93
    v_max_f32 v93, 0, v93
    v_add_f32 v93, 0x3727c5ac, v93
    v_rsq_f32 v93, v93
    v_fma_f32 v19, v92, v64, v19
    v_mul_f32 v19, v19, v93
L_finst:
    v_cvt_pk_bf16_f32 v16, v16, v17
    v_cvt_pk_bf16_f32 v17, v18, v19
    buffer_store_dwordx2 v[16:17], v44, s[24:27], s88 offen sc1
    s_add_u32 s86, s38, 1
    s_and_b32 s86, s86, 3
    s_lshl_b32 s87, s36, 2
    s_add_u32 s86, s86, s87
    s_lshl_b32 m0, s86, 12
    s_lshl_b32 s86, s86, 15
    buffer_load_dwordx4 v200, s[8:11], s86 offen offset:0 lds
    s_add_u32 s86, s86, 7168
    buffer_load_dwordx4 v201, s[8:11], s86 offen offset:1024 lds
    s_add_u32 s86, s86, 7168
    buffer_load_dwordx4 v200, s[8:11], s86 offen offset:2048 lds
    s_add_u32 s86, s86, 7168
    buffer_load_dwordx4 v201, s[8:11], s86 offen offset:3072 lds
    s_waitcnt vmcnt(5)
    s_branch L_find

L_kvslow:
    s_mov_b32 s96, 40000
L_rp4:
    s_mov_b64 exec, vcc
    buffer_load_dword v14, v223, s[20:23], 0 offen sc1
    s_sub_u32 s96, s96, 1
    s_cbranch_scc1 L_rp4x
    s_waitcnt vmcnt(0)
    v_and_b32 v14, -16, v14
    v_cmp_ne_u32 vcc, s39, v14
    s_nop 0
    s_cmp_eq_u64 vcc, 0
    s_cbranch_scc0 L_rp4
L_rp4x:
    s_mov_b64 exec, -1
    s_branch L_kvok

L_alt5:
s_mov_b64 exec, s[100:101]
buffer_store_dwordx4 v[68:71], v8, s[32:35], s93 offen sc1
s_mov_b64 exec, -1
s_branch L_join6
L_alt7:
s_waitcnt vmcnt(4)
s_and_b64 exec, s[100:101], 1
buffer_store_dword v10, off, s[20:23], s90 offset:0 sc1
s_mov_b64 exec, -1
s_branch L_join8
L_wfslow:
    s_mov_b32 s96, 40000
L_rp9:
    s_mov_b64 exec, vcc
    buffer_load_dword v100, v130, s[20:23], 0 offen sc1
    s_sub_u32 s96, s96, 1
    s_cbranch_scc1 L_rp9x
    s_waitcnt vmcnt(0)
    v_and_b32 v100, -16, v100
    v_cmp_ne_u32 vcc, s39, v100
    s_nop 0
    s_cmp_eq_u64 vcc, 0
    s_cbranch_scc0 L_rp9
L_rp9x:
    s_mov_b64 exec, -1
    s_branch L_wfok

L_alt10:
buffer_store_dwordx4 v[48:51], v8, s[32:35], s93 offen offset:1024 sc1
s_branch L_join11
L_alt14:
buffer_store_dwordx4 v[68:71], v8, s[32:35], s93 offen sc1
s_waitcnt vmcnt(0)
s_mov_b64 exec, 1
buffer_store_dword v10, off, s[20:23], s90 offset:0 sc1
s_mov_b64 exec, -1
s_branch L_join15
L_fb:
    s_cmp_eq_u64 s[100:101], -1
    s_cbranch_scc1 L_fb1
    v_mov_b32 v10, 0xff800000
    v_mov_b32 v11, v8
    s_mov_b32 s96, 64
L_fbm12:
    buffer_load_dwordx4 v[24:27], v11, s[24:27], 0 offen sc1
    s_waitcnt vmcnt(0)
    v_add_u32 v11, 2112, v11
    v_mfma_f32_32x32x16_bf16 v[36:51], v[24:27], v[16:19], 0
    s_nop 11
    v_max3_f32 v10, v36, v37, v10
    v_max3_f32 v10, v38, v39, v10
    v_max3_f32 v10, v40, v41, v10
    v_max3_f32 v10, v42, v43, v10
    v_max3_f32 v10, v44, v45, v10
    v_max3_f32 v10, v46, v47, v10
    v_max3_f32 v10, v48, v49, v10
    v_max3_f32 v10, v50, v51, v10
    s_sub_u32 s96, s96, 1
    s_cmp_lg_u32 s96, 0
    s_cbranch_scc1 L_fbm12
    v_mov_b32 v11, v10
    s_nop 1
    v_permlane32_swap_b32 v10, v11
    v_max_f32 v10, v10, v11
    v_mov_b32 v68, 0
    v_mov_b32 v69, 0
    v_mov_b32 v70, 0
    v_mov_b32 v71, 0
    v_mov_b32 v72, 0
    v_mov_b32 v73, 0
    v_mov_b32 v74, 0
    v_mov_b32 v75, 0
    v_mov_b32 v76, 0
    v_mov_b32 v77, 0
    v_mov_b32 v78, 0
    v_mov_b32 v79, 0
    v_mov_b32 v80, 0
    v_mov_b32 v81, 0
    v_mov_b32 v82, 0
    v_mov_b32 v83, 0
    v_mov_b32 v11, v8
    v_mov_b32 v12, v5
    s_mov_b32 s96, 64
L_fbs13:
    buffer_load_dwordx4 v[24:27], v11, s[24:27], 0 offen sc1
    buffer_load_dwordx4 v[28:31], v12, s[24:27], 0 offen sc1
    buffer_load_dwordx4 v[32:35], v12, s[24:27], 0 offen offset:544 sc1
    s_waitcnt vmcnt(0)
    v_add_u32 v11, 2112, v11
    v_add_u32 v12, 2112, v12
    v_mfma_f32_32x32x16_bf16 v[36:51], v[24:27], v[16:19], 0
    s_nop 11
    v_sub_f32 v36, v36, v10
    v_sub_f32 v37, v37, v10
    v_sub_f32 v38, v38, v10
    v_sub_f32 v39, v39, v10
    v_sub_f32 v40, v40, v10
    v_sub_f32 v41, v41, v10
    v_sub_f32 v42, v42, v10
    v_sub_f32 v43, v43, v10
    v_sub_f32 v44, v44, v10
    v_sub_f32 v45, v45, v10
    v_sub_f32 v46, v46, v10
    v_sub_f32 v47, v47, v10
    v_sub_f32 v48, v48, v10
    v_sub_f32 v49, v49, v10
    v_sub_f32 v50, v50, v10
    v_sub_f32 v51, v51, v10
    v_exp_f32 v36, v36
    v_exp_f32 v37, v37
    v_exp_f32 v38, v38
    v_exp_f32 v39, v39
    v_exp_f32 v40, v40
    v_exp_f32 v41, v41
    v_exp_f32 v42, v42
    v_exp_f32 v43, v43
    v_exp_f32 v44, v44
    v_exp_f32 v45, v45
    v_exp_f32 v46, v46
    v_exp_f32 v47, v47
    v_exp_f32 v48, v48
    v_exp_f32 v49, v49
    v_exp_f32 v50, v50
    v_exp_f32 v51, v51
    v_smfmac_f32_32x32x32_bf16 v[68:83], v[28:31], v[36:43], v1
    s_nop 0
    v_smfmac_f32_32x32x32_bf16 v[68:83], v[32:35], v[44:51], v1
    s_sub_u32 s96, s96, 1
    s_cmp_lg_u32 s96, 0
    s_nop 9
    s_cbranch_scc1 L_fbs13
    v_rcp_f32 v10, v76
    s_nop 0
    v_pk_mul_f32 v[68:69], v[68:69], v[10:11] op_sel_hi:[1,0]
    v_pk_mul_f32 v[70:71], v[70:71], v[10:11] op_sel_hi:[1,0]
    v_pk_mul_f32 v[72:73], v[72:73], v[10:11] op_sel_hi:[1,0]
    v_pk_mul_f32 v[74:75], v[74:75], v[10:11] op_sel_hi:[1,0]
    v_cvt_pk_bf16_f32 v68, v68, v69
    v_cvt_pk_bf16_f32 v69, v70, v71
    v_cvt_pk_bf16_f32 v70, v72, v73
    v_cvt_pk_bf16_f32 v71, v74, v75
    v_mov_b32 v10, s39
    s_cmp_eq_u32 s85, 0
    s_cbranch_scc1 L_alt14
    buffer_store_dwordx4 v[68:71], v8, s[32:35], s93 offen
    s_waitcnt vmcnt(0)
    s_mov_b64 exec, 1
    buffer_store_dword v10, off, s[20:23], s90 offset:0
    s_mov_b64 exec, -1
L_join15:
L_fb1:
    v_mov_b32 v10, 0xff800000
    v_mov_b32 v11, v8
    s_mov_b32 s96, 64
L_fbm16:
    buffer_load_dwordx4 v[24:27], v11, s[24:27], 0 offen sc1
    s_waitcnt vmcnt(0)
    v_add_u32 v11, 2112, v11
    v_mfma_f32_32x32x16_bf16 v[36:51], v[24:27], v[20:23], 0
    s_nop 11
    v_max3_f32 v10, v36, v37, v10
    v_max3_f32 v10, v38, v39, v10
    v_max3_f32 v10, v40, v41, v10
    v_max3_f32 v10, v42, v43, v10
    v_max3_f32 v10, v44, v45, v10
    v_max3_f32 v10, v46, v47, v10
    v_max3_f32 v10, v48, v49, v10
    v_max3_f32 v10, v50, v51, v10
    s_sub_u32 s96, s96, 1
    s_cmp_lg_u32 s96, 0
    s_cbranch_scc1 L_fbm16
    v_mov_b32 v11, v10
    s_nop 1
    v_permlane32_swap_b32 v10, v11
    v_max_f32 v10, v10, v11
    v_mov_b32 v84, 0
    v_mov_b32 v85, 0
    v_mov_b32 v86, 0
    v_mov_b32 v87, 0
    v_mov_b32 v88, 0
    v_mov_b32 v89, 0
    v_mov_b32 v90, 0
    v_mov_b32 v91, 0
    v_mov_b32 v92, 0
    v_mov_b32 v93, 0
    v_mov_b32 v94, 0
    v_mov_b32 v95, 0
    v_mov_b32 v96, 0
    v_mov_b32 v97, 0
    v_mov_b32 v98, 0
    v_mov_b32 v99, 0
    v_mov_b32 v11, v8
    v_mov_b32 v12, v5
    s_mov_b32 s96, 64
L_fbs17:
    buffer_load_dwordx4 v[24:27], v11, s[24:27], 0 offen sc1
    buffer_load_dwordx4 v[28:31], v12, s[24:27], 0 offen sc1
    buffer_load_dwordx4 v[32:35], v12, s[24:27], 0 offen offset:544 sc1
    s_waitcnt vmcnt(0)
    v_add_u32 v11, 2112, v11
    v_add_u32 v12, 2112, v12
    v_mfma_f32_32x32x16_bf16 v[36:51], v[24:27], v[20:23], 0
    s_nop 11
    v_sub_f32 v36, v36, v10
    v_sub_f32 v37, v37, v10
    v_sub_f32 v38, v38, v10
    v_sub_f32 v39, v39, v10
    v_sub_f32 v40, v40, v10
    v_sub_f32 v41, v41, v10
    v_sub_f32 v42, v42, v10
    v_sub_f32 v43, v43, v10
    v_sub_f32 v44, v44, v10
    v_sub_f32 v45, v45, v10
    v_sub_f32 v46, v46, v10
    v_sub_f32 v47, v47, v10
    v_sub_f32 v48, v48, v10
    v_sub_f32 v49, v49, v10
    v_sub_f32 v50, v50, v10
    v_sub_f32 v51, v51, v10
    v_exp_f32 v36, v36
    v_exp_f32 v37, v37
    v_exp_f32 v38, v38
    v_exp_f32 v39, v39
    v_exp_f32 v40, v40
    v_exp_f32 v41, v41
    v_exp_f32 v42, v42
    v_exp_f32 v43, v43
    v_exp_f32 v44, v44
    v_exp_f32 v45, v45
    v_exp_f32 v46, v46
    v_exp_f32 v47, v47
    v_exp_f32 v48, v48
    v_exp_f32 v49, v49
    v_exp_f32 v50, v50
    v_exp_f32 v51, v51
    v_smfmac_f32_32x32x32_bf16 v[84:99], v[28:31], v[36:43], v1
    s_nop 0
    v_smfmac_f32_32x32x32_bf16 v[84:99], v[32:35], v[44:51], v1
    s_sub_u32 s96, s96, 1
    s_cmp_lg_u32 s96, 0
    s_nop 9
    s_cbranch_scc1 L_fbs17
    s_branch L_fbdone

L_oslow:
    s_mov_b32 s96, 40000
L_poll18:
    buffer_load_dword v14, v159, s[20:23], 0 offen sc1
    s_sub_u32 s96, s96, 1
    s_cbranch_scc1 L_pdone19
    s_waitcnt vmcnt(0)
    v_cmp_ne_u32 vcc, s39, v14
    s_nop 0
    s_cmp_eq_u64 vcc, 0
    s_cbranch_scc0 L_poll18
L_pdone19:
    buffer_load_dwordx4 v[116:119], v11, s[32:35], s72 offen offset:0 sc1
    buffer_load_dwordx4 v[120:123], v11, s[32:35], s72 offen offset:2048 sc1
    buffer_load_dwordx4 v[124:127], v11, s[32:35], s73 offen offset:0 sc1
    buffer_load_dwordx4 v[128:131], v11, s[32:35], s73 offen offset:2048 sc1
    buffer_load_dwordx4 v[132:135], v11, s[32:35], s74 offen offset:0 sc1
    buffer_load_dwordx4 v[136:139], v11, s[32:35], s74 offen offset:2048 sc1
    buffer_load_dwordx4 v[140:143], v11, s[32:35], s75 offen offset:0 sc1
    buffer_load_dwordx4 v[72:75], v11, s[32:35], s75 offen offset:2048 sc1
    s_waitcnt vmcnt(0)
    s_branch L_ook

L_alt20:
s_waitcnt vmcnt(0)
s_mov_b64 exec, 1
buffer_store_dword v10, off, s[20:23], s90 offset:128 sc1
s_mov_b64 exec, -1
s_branch L_join21
L_xslow1:
    s_mov_b32 s96, 40000
L_poll22:
    buffer_load_dword v14, v159, s[20:23], 0 offen offset:128 sc1
    s_sub_u32 s96, s96, 1
    s_cbranch_scc1 L_pdone23
    s_waitcnt vmcnt(0)
    v_cmp_ne_u32 vcc, s39, v14
    s_nop 0
    s_cmp_eq_u64 vcc, 0
    s_cbranch_scc0 L_poll22
L_pdone23:
    s_branch L_xok1

L_alt24:
buffer_store_dwordx4 v[144:147], v8, s[32:35], s91 offen sc1
s_branch L_join25
L_alt26:
s_waitcnt vmcnt(6)
s_mov_b64 exec, 1
buffer_store_dword v10, off, s[20:23], s90 offset:256 sc1
s_mov_b64 exec, -1
s_branch L_join27
L_alt28:
buffer_store_dwordx4 v[148:151], v8, s[32:35], s91 offen offset:1024 sc1
s_branch L_join29
L_xslow2:
    s_mov_b32 s96, 40000
L_poll30:
    buffer_load_dword v14, v159, s[20:23], 0 offen offset:256 sc1
    s_sub_u32 s96, s96, 1
    s_cbranch_scc1 L_pdone31
    s_waitcnt vmcnt(0)
    v_cmp_ne_u32 vcc, s39, v14
    s_nop 0
    s_cmp_eq_u64 vcc, 0
    s_cbranch_scc0 L_poll30
L_pdone31:
    s_branch L_xok2

L_alt32:
buffer_store_dwordx2 v[72:73], v12, s[32:35], 0 offen sc1
s_branch L_join33
L_alt34:
s_waitcnt vmcnt(5)
s_mov_b64 exec, 1
buffer_store_dword v10, off, s[20:23], s90 offset:384 sc1
s_mov_b64 exec, -1
s_branch L_join35
L_xslow3:
    s_mov_b32 s96, 40000
L_poll36:
    buffer_load_dword v14, v159, s[20:23], 0 offen offset:384 sc1
    s_sub_u32 s96, s96, 1
    s_cbranch_scc1 L_pdone37
    s_waitcnt vmcnt(0)
    v_cmp_ne_u32 vcc, s39, v14
    s_nop 0
    s_cmp_eq_u64 vcc, 0
    s_cbranch_scc0 L_poll36
L_pdone37:
    s_branch L_xok3

L_alt38:
buffer_store_dwordx4 v[64:67], v6, s[32:35], 0 offen offset:0 sc1
buffer_store_dwordx4 v[68:71], v6, s[32:35], 0 offen offset:1024 sc1
buffer_store_dwordx4 v[72:75], v7, s[32:35], 0 offen offset:0 sc1
buffer_store_dwordx4 v[76:79], v7, s[32:35], 0 offen offset:1024 sc1
s_branch L_join39
L_alt40:
s_waitcnt vmcnt(0)
s_mov_b64 exec, 1
buffer_store_dword v10, off, s[20:23], s90 offset:512 sc1
s_mov_b64 exec, -1
s_branch L_join41
L_xslow4:
    s_mov_b32 s96, 40000
L_poll42:
    buffer_load_dword v14, v159, s[20:23], 0 offen offset:512 sc1
    s_sub_u32 s96, s96, 1
    s_cbranch_scc1 L_pdone43
    s_waitcnt vmcnt(0)
    v_cmp_ne_u32 vcc, s39, v14
    s_nop 0
    s_cmp_eq_u64 vcc, 0
    s_cbranch_scc0 L_poll42
L_pdone43:
    s_branch L_xok4

L_alt44:
buffer_store_dwordx4 v[64:67], v6, s[32:35], s93 offen offset:0 sc1
buffer_store_dwordx4 v[68:71], v6, s[32:35], s93 offen offset:1024 sc1
buffer_store_dwordx4 v[72:75], v7, s[32:35], s93 offen offset:0 sc1
buffer_store_dwordx4 v[76:79], v7, s[32:35], s93 offen offset:1024 sc1
s_branch L_join45
L_alt46:
s_waitcnt vmcnt(7)
s_mov_b64 exec, 1
buffer_store_dword v10, off, s[20:23], s90 offset:640 sc1
s_mov_b64 exec, -1
s_branch L_join47
L_xslow5:
    s_mov_b32 s96, 40000
L_poll48:
    buffer_load_dword v14, v159, s[20:23], 0 offen offset:640 sc1
    s_sub_u32 s96, s96, 1
    s_cbranch_scc1 L_pdone49
    s_waitcnt vmcnt(0)
    v_cmp_ne_u32 vcc, s39, v14
    s_nop 0
    s_cmp_eq_u64 vcc, 0
    s_cbranch_scc0 L_poll48
L_pdone49:
    s_branch L_xok5

L_end:
    s_endpgm
.section .rodata,"a"
.p2align 6
.amdhsa_kernel sequential_preLN__grouped_kv_mqa__dense_activation_relu__prompt_kernel
  .amdhsa_next_free_vgpr 512
  .amdhsa_next_free_sgpr 102
  .amdhsa_accum_offset 256
  .amdhsa_group_segment_fixed_size 0
  .amdhsa_kernarg_size 88
  .amdhsa_user_sgpr_count 2
  .amdhsa_user_sgpr_kernarg_segment_ptr 1
  .amdhsa_system_sgpr_workgroup_id_x 1
  .amdhsa_float_denorm_mode_32 3
.end_amdhsa_kernel
```
